```python
import torch

def _softmax(x, axis=-1):
    return torch.softmax(x, dim=axis)
def _gelu(x):
    return torch.nn.functional.gelu(x, approximate="tanh")
def _silu(x):
    return torch.nn.functional.silu(x)
def _sigmoid(x):
    return torch.sigmoid(x)
def _layernorm(x, axis=-1, eps=1e-5):
    m = x.mean(dim=axis, keepdim=True)
    v = x.var(dim=axis, keepdim=True, unbiased=False)
    return (x - m) / torch.sqrt(v + eps)
def _scatter_add(tgt, idx, src, axis=0):
    return tgt.clone().index_add_(axis, idx, src)
def _segment_sum(src, seg, n):
    out = torch.zeros((n,) + src.shape[1:], dtype=src.dtype)
    return out.index_add_(0, seg, src)
def _pad(x, pw):
    flat = tuple(v for pair in reversed(pw) for v in pair)
    return torch.nn.functional.pad(x, flat)

kernel_name = 'recurrent_scan__mha_block_cached__moe_arch_mod__decode'

def setup_inputs():

    _w = (lambda a: (lambda t: t.to(torch.bfloat16) if t.is_floating_point() else t)(torch.as_tensor(a)))
    def _A_setup():
        B, Sq, D = 2, 1, 640
        H, Sk, Dh = 32, 8192, 192
        return {
            "x": _w((lambda *s: torch.randn(*s, dtype=torch.bfloat16) * 0.05)(B, Sq, D)),
            "k_cache": _w((lambda *s: torch.randn(*s, dtype=torch.bfloat16) * 1.6)(B, H, Sk, Dh)),
            "v_cache": _w((lambda *s: torch.randn(*s, dtype=torch.bfloat16) * 0.2)(B, H, Sk, Dh)),
            "wq": _w((lambda *s: torch.randn(*s, dtype=torch.bfloat16) * 1.6)(D, H * Dh) * (D ** -0.5)),
            "wo": _w((lambda *s: torch.randn(*s, dtype=torch.bfloat16) * 0.2)(H * Dh, D) * ((H * Dh) ** -0.5)),
        }
    _A_in = _A_setup()

    def _B_setup():
        B, S, D, F, C = 2, 1, 640, 1536, 1
        return {
            "x": _w((lambda *s: torch.randn(*s, dtype=torch.bfloat16) * 0.05)(B, S, D)),
            "w_r": _w((lambda *s: torch.randn(*s, dtype=torch.bfloat16) * 0.1)(D)),
            "w_gate": _w((lambda *s: torch.randn(*s, dtype=torch.bfloat16) * 0.1)(D, F)),
            "w_up": _w((lambda *s: torch.randn(*s, dtype=torch.bfloat16) * 0.1)(D, F)),
            "w_down": _w((lambda *s: torch.randn(*s, dtype=torch.bfloat16) * 0.1)(F, D)),
        }
    _B_in = _B_setup()

    return {
        "A_x": _A_in["x"],
        "A_k_cache": _A_in["k_cache"],
        "A_v_cache": _A_in["v_cache"],
        "A_wq": _A_in["wq"],
        "A_wo": _A_in["wo"],
        "B_x": _B_in["x"],
        "B_w_r": _B_in["w_r"],
        "B_w_gate": _B_in["w_gate"],
        "B_w_up": _B_in["w_up"],
        "B_w_down": _B_in["w_down"],
    }

def reference(A_x, A_k_cache, A_v_cache, A_wq, A_wo, B_x, B_w_r, B_w_gate, B_w_up, B_w_down):
    def _A_ref(x, k_cache, v_cache, wq, wo):
        B, Sq, D = x.shape
        H, Dh = 32, 192
        q = (lambda x, *d: x.permute(*d))((x @ wq).reshape(B, Sq, H, Dh), 0, 2, 1, 3)
        scores = torch.einsum("bhqd,bhkd->bhqk", q, k_cache) * (Dh ** -0.5)
        p = _softmax(scores, axis=-1)
        o = torch.einsum("bhqk,bhkd->bhqd", p, v_cache)
        return (lambda x, *d: x.permute(*d))(o, 0, 2, 1, 3).reshape(B, Sq, H * Dh) @ wo

    def _B_ref(x, w_r, w_gate, w_up, w_down):
        B, S, D = x.shape
        C = 1
        r = x @ w_r
        idx = torch.argsort(-r, axis=-1)[:, :C]
        idx_e = (lambda x, n, axis: torch.repeat_interleave(x, n, dim=axis))(idx.reshape(B, C, 1), D, axis=2)
        x_sel = (lambda x, i, axis: torch.take_along_dim(x, i, dim=axis))(x, idx_e, axis=1)
        g = _silu(x_sel @ w_gate)
        u = x_sel @ w_up
        y = (g * u) @ w_down
        r_sel = _sigmoid((lambda x, i, axis: torch.take_along_dim(x, i, dim=axis))(r, idx, axis=1))
        y = y * r_sel.reshape(B, C, 1)
        b_off = (torch.arange(B) * S).reshape(B, 1)
        flat_idx = (idx + b_off).reshape(B * C)
        zero = (x * 0.0).reshape(B * S, D)
        upd = _scatter_add(zero, flat_idx, y.reshape(B * C, D), axis=0)
        return x + upd.reshape(B, S, D)

    x = A_x
    xn = _layernorm(x, axis=-1)
    s = _A_ref(xn, A_k_cache, A_v_cache, A_wq, A_wo)
    g = _silu(_B_ref(xn, B_w_r, B_w_gate, B_w_up, B_w_down))
    return x + s * g
```

```asm
; @launch grid=(256,1,1) block=(512,1,1) lds=13632
.amdgcn_target "amdgcn-amd-amdhsa--gfx950"
.text
.globl recurrent_scan__mha_block_cached__moe_arch_mod__decode_kernel
.p2align 8
.type recurrent_scan__mha_block_cached__moe_arch_mod__decode_kernel,@function
recurrent_scan__mha_block_cached__moe_arch_mod__decode_kernel:
    s_cmp_ge_u32 s2, 256
    s_cbranch_scc1 L_end
    s_load_dwordx16 s[8:23], s[0:1], 0
    s_load_dwordx8 s[24:31], s[0:1], 64
    s_load_dwordx2 s[32:33], s[0:1], 96
    v_lshrrev_b32 v2, 6, v0
    v_and_b32 v0, 63, v0
    v_readfirstlane_b32 s3, v2
    s_lshr_b32 s4, s2, 3
    s_and_b32 s5, s2, 7
    v_lshrrev_b32 v62, 3, v0
    v_mul_u32_u24 v2, 384, v62
    v_and_b32 v63, 7, v0
    v_lshl_add_u32 v1, v63, 4, v2
    s_lshr_b32 s6, s3, 2
    s_and_b32 s7, s3, 3
    s_movk_i32 s50, 2560
    s_mov_b32 s51, 0x20000
    s_mov_b32 s55, 0x20000
    s_cmp_eq_u32 s6, 0
    s_cbranch_scc1 L_flood
    s_and_b32 s71, s2, 1
    s_mul_i32 s71, s71, 320
    s_sub_u32 s34, s2, 192
    s_lshr_b32 s35, s34, 2
    s_lshr_b32 s70, s2, 1
    s_cmp_lt_u32 s2, 192
    s_cselect_b32 s70, s70, s35
    s_cselect_b32 s77, 4, 1
    s_mul_i32 s77, s77, 3072
    s_mul_i32 s54, s77, 640
    s_lshl_b32 s70, s70, 7
    s_mul_i32 s34, s7, 80
    s_add_u32 s69, s71, s34
    s_mul_i32 s34, s69, s77
    s_add_u32 s74, s34, s70
    s_mul_i32 s34, s77, 10
    v_mul_lo_u32 v61, v62, s34
    v_lshl_add_u32 v61, v63, 4, v61
    v_mul_u32_u24 v59, 40, v0
    s_waitcnt lgkmcnt(0)
    s_mov_b64 s[48:49], s[8:9]
    buffer_load_dwordx4 v[16:19], v59, s[48:51], 0 offen
    buffer_load_dwordx4 v[20:23], v59, s[48:51], 0 offen offset:16
    buffer_load_dwordx2 v[24:25], v59, s[48:51], 0 offen offset:32
    s_bitcmp1_b32 s2, 1
    s_cselect_b32 s52, s24, s22
    s_cselect_b32 s53, s25, s23
    s_cmp_lt_u32 s2, 192
    s_cselect_b32 s52, s14, s52
    s_cselect_b32 s53, s15, s53
    buffer_load_dwordx4 v[64:67], v61, s[52:55], s74 offen nt
    s_add_u32 s74, s74, s77
    buffer_load_dwordx4 v[68:71], v61, s[52:55], s74 offen nt
    s_add_u32 s74, s74, s77
    buffer_load_dwordx4 v[72:75], v61, s[52:55], s74 offen nt
    s_add_u32 s74, s74, s77
    buffer_load_dwordx4 v[76:79], v61, s[52:55], s74 offen nt
    s_add_u32 s74, s74, s77
    buffer_load_dwordx4 v[80:83], v61, s[52:55], s74 offen nt
    s_add_u32 s74, s74, s77
    buffer_load_dwordx4 v[84:87], v61, s[52:55], s74 offen nt
    s_add_u32 s74, s74, s77
    buffer_load_dwordx4 v[88:91], v61, s[52:55], s74 offen nt
    s_add_u32 s74, s74, s77
    buffer_load_dwordx4 v[92:95], v61, s[52:55], s74 offen nt
    s_add_u32 s74, s74, s77
    buffer_load_dwordx4 v[96:99], v61, s[52:55], s74 offen nt
    s_add_u32 s74, s74, s77
    buffer_load_dwordx4 v[100:103], v61, s[52:55], s74 offen nt
    s_mov_b64 exec, 0xffff
    v_lshlrev_b32 v2, 2, v0
    v_mov_b32 v4, 0
    ds_write_b32 v2, v4 offset:11008
    s_mov_b64 exec, -1
    s_waitcnt lgkmcnt(0)
    s_barrier
    s_lshl_b32 s68, s6, 5
    s_add_u32 s68, s68, s4
    s_mul_i32 s68, s68, 3145728
    s_mov_b32 s38, 3145728
    s_mov_b32 s39, 0x20000
    s_lshl_b32 s72, s4, 1
    s_add_u32 s72, s72, s6
    s_lshl_b32 s72, s72, 8
    s_add_u32 s72, s72, 327680
    s_mov_b32 s75, 0x1000000
    s_mov_b32 s46, 1835008
    s_mov_b32 s47, 0x20000
    s_add_u32 s36, s10, s68
    s_addc_u32 s37, s11, 0
    s_mov_b64 s[44:45], s[32:33]
    s_add_u32 s40, s12, s68
    s_addc_u32 s41, s13, 0
    s_mov_b32 s42, 3145728
    s_mov_b32 s43, 0x20000
    s_mov_b64 s[56:57], s[26:27]
    s_mov_b32 s58, 1966080
    s_mov_b32 s59, 0x20000
    s_mov_b64 s[60:61], s[20:21]
    s_movk_i32 s62, 1280
    s_mov_b32 s63, 0x20000
    s_mov_b64 s[64:65], s[28:29]
    s_movk_i32 s66, 2560
    s_mov_b32 s67, 0x20000
    s_mov_b32 s78, 0xff00ff00
    s_mov_b32 s79, 0xff00ff00
    s_mov_b32 s82, 0x05040100
    s_mov_b32 s83, 0x07060302
    s_lshl_b32 s73, s5, 2
    s_add_u32 s73, s73, s7
    s_lshl_b32 s73, s73, 3
    s_add_u32 s73, s73, s72
    v_mov_b32 v56, 1073741824
    v_writelane_b32 v56, s73, 0
    s_lshl_b32 s34, s7, 2
    v_mov_b32 v57, s34
    v_mov_b32 v58, 1
    s_waitcnt vmcnt(10)
    v_lshlrev_b32 v128, 16, v16
    v_and_b32 v129, 0xffff0000, v16
    v_lshlrev_b32 v130, 16, v17
    v_and_b32 v131, 0xffff0000, v17
    v_lshlrev_b32 v132, 16, v18
    v_and_b32 v133, 0xffff0000, v18
    v_lshlrev_b32 v134, 16, v19
    v_and_b32 v135, 0xffff0000, v19
    v_lshlrev_b32 v136, 16, v20
    v_and_b32 v137, 0xffff0000, v20
    v_lshlrev_b32 v138, 16, v21
    v_and_b32 v139, 0xffff0000, v21
    v_lshlrev_b32 v140, 16, v22
    v_and_b32 v141, 0xffff0000, v22
    v_lshlrev_b32 v142, 16, v23
    v_and_b32 v143, 0xffff0000, v23
    v_lshlrev_b32 v144, 16, v24
    v_and_b32 v145, 0xffff0000, v24
    v_lshlrev_b32 v146, 16, v25
    v_and_b32 v147, 0xffff0000, v25
    v_add_f32 v14, v128, v129
    v_add_f32 v15, v130, v131
    v_add_f32 v14, v14, v132
    v_add_f32 v15, v15, v133
    v_add_f32 v14, v14, v134
    v_add_f32 v15, v15, v135
    v_add_f32 v14, v14, v136
    v_add_f32 v15, v15, v137
    v_add_f32 v14, v14, v138
    v_add_f32 v15, v15, v139
    v_add_f32 v14, v14, v140
    v_add_f32 v15, v15, v141
    v_add_f32 v14, v14, v142
    v_add_f32 v15, v15, v143
    v_add_f32 v14, v14, v144
    v_add_f32 v15, v15, v145
    v_add_f32 v14, v14, v146
    v_add_f32 v15, v15, v147
    v_add_f32 v14, v14, v15
    v_mov_b32 v15, v14
    s_nop 1
    v_permlane16_swap_b32 v14, v15
    v_add_f32 v14, v14, v15
    s_nop 1
    v_add_f32_dpp v14, v14, v14 row_ror:8 row_mask:0xf bank_mask:0xf
    s_nop 1
    v_add_f32_dpp v14, v14, v14 row_ror:4 row_mask:0xf bank_mask:0xf
    s_nop 1
    v_add_f32_dpp v14, v14, v14 row_ror:2 row_mask:0xf bank_mask:0xf
    s_nop 1
    v_add_f32_dpp v14, v14, v14 row_ror:1 row_mask:0xf bank_mask:0xf
    v_mul_f32 v14, 0x3acccccd, v14
    v_sub_f32 v32, v128, v14
    v_sub_f32 v33, v129, v14
    v_sub_f32 v34, v130, v14
    v_sub_f32 v35, v131, v14
    v_sub_f32 v36, v132, v14
    v_sub_f32 v37, v133, v14
    v_sub_f32 v38, v134, v14
    v_sub_f32 v39, v135, v14
    v_sub_f32 v40, v136, v14
    v_sub_f32 v41, v137, v14
    v_sub_f32 v42, v138, v14
    v_sub_f32 v43, v139, v14
    v_sub_f32 v44, v140, v14
    v_sub_f32 v45, v141, v14
    v_sub_f32 v46, v142, v14
    v_sub_f32 v47, v143, v14
    v_sub_f32 v48, v144, v14
    v_sub_f32 v49, v145, v14
    v_sub_f32 v50, v146, v14
    v_sub_f32 v51, v147, v14
    v_mul_f32 v12, v32, v32
    v_mul_f32 v13, v33, v33
    v_fmac_f32 v12, v34, v34
    v_fmac_f32 v13, v35, v35
    v_fmac_f32 v12, v36, v36
    v_fmac_f32 v13, v37, v37
    v_fmac_f32 v12, v38, v38
    v_fmac_f32 v13, v39, v39
    v_fmac_f32 v12, v40, v40
    v_fmac_f32 v13, v41, v41
    v_fmac_f32 v12, v42, v42
    v_fmac_f32 v13, v43, v43
    v_fmac_f32 v12, v44, v44
    v_fmac_f32 v13, v45, v45
    v_fmac_f32 v12, v46, v46
    v_fmac_f32 v13, v47, v47
    v_fmac_f32 v12, v48, v48
    v_fmac_f32 v13, v49, v49
    v_fmac_f32 v12, v50, v50
    v_fmac_f32 v13, v51, v51
    v_add_f32 v12, v12, v13
    v_cvt_pk_bf16_f32 v14, v14, v14
    v_and_b32 v14, 0xffff0000, v14
    v_mov_b32 v13, v12
    s_nop 1
    v_permlane16_swap_b32 v12, v13
    v_add_f32 v12, v12, v13
    s_nop 1
    v_add_f32_dpp v12, v12, v12 row_ror:8 row_mask:0xf bank_mask:0xf
    s_nop 1
    v_add_f32_dpp v12, v12, v12 row_ror:4 row_mask:0xf bank_mask:0xf
    s_nop 1
    v_add_f32_dpp v12, v12, v12 row_ror:2 row_mask:0xf bank_mask:0xf
    s_nop 1
    v_add_f32_dpp v12, v12, v12 row_ror:1 row_mask:0xf bank_mask:0xf
    v_sub_f32 v128, v128, v14
    v_sub_f32 v129, v129, v14
    v_sub_f32 v130, v130, v14
    v_sub_f32 v131, v131, v14
    v_sub_f32 v132, v132, v14
    v_sub_f32 v133, v133, v14
    v_sub_f32 v134, v134, v14
    v_sub_f32 v135, v135, v14
    v_sub_f32 v136, v136, v14
    v_sub_f32 v137, v137, v14
    v_sub_f32 v138, v138, v14
    v_sub_f32 v139, v139, v14
    v_sub_f32 v140, v140, v14
    v_sub_f32 v141, v141, v14
    v_sub_f32 v142, v142, v14
    v_sub_f32 v143, v143, v14
    v_sub_f32 v144, v144, v14
    v_sub_f32 v145, v145, v14
    v_sub_f32 v146, v146, v14
    v_sub_f32 v147, v147, v14
    v_mul_f32 v12, 0x3acccccd, v12
    v_cvt_pk_bf16_f32 v16, v128, v129
    v_cvt_pk_bf16_f32 v17, v130, v131
    v_cvt_pk_bf16_f32 v18, v132, v133
    v_cvt_pk_bf16_f32 v19, v134, v135
    v_cvt_pk_bf16_f32 v20, v136, v137
    v_cvt_pk_bf16_f32 v21, v138, v139
    v_cvt_pk_bf16_f32 v22, v140, v141
    v_cvt_pk_bf16_f32 v23, v142, v143
    v_cvt_pk_bf16_f32 v24, v144, v145
    v_cvt_pk_bf16_f32 v25, v146, v147
    v_cvt_pk_bf16_f32 v12, v12, v12
    v_and_b32 v12, 0xffff0000, v12
    v_add_f32 v12, 0x3727c5ac, v12
    v_cvt_pk_bf16_f32 v12, v12, v12
    v_and_b32 v12, 0xffff0000, v12
    v_sqrt_f32 v12, v12
    v_lshlrev_b32 v128, 16, v16
    v_and_b32 v129, 0xffff0000, v16
    v_lshlrev_b32 v130, 16, v17
    v_and_b32 v131, 0xffff0000, v17
    v_lshlrev_b32 v132, 16, v18
    v_and_b32 v133, 0xffff0000, v18
    v_lshlrev_b32 v134, 16, v19
    v_and_b32 v135, 0xffff0000, v19
    v_lshlrev_b32 v136, 16, v20
    v_and_b32 v137, 0xffff0000, v20
    v_lshlrev_b32 v138, 16, v21
    v_and_b32 v139, 0xffff0000, v21
    v_lshlrev_b32 v140, 16, v22
    v_and_b32 v141, 0xffff0000, v22
    v_lshlrev_b32 v142, 16, v23
    v_and_b32 v143, 0xffff0000, v23
    v_lshlrev_b32 v144, 16, v24
    v_and_b32 v145, 0xffff0000, v24
    v_lshlrev_b32 v146, 16, v25
    v_and_b32 v147, 0xffff0000, v25
    v_cvt_pk_bf16_f32 v12, v12, v12
    v_and_b32 v12, 0xffff0000, v12
    v_rcp_f32 v13, v12
    s_nop 0
    v_mul_f32 v32, v128, v13
    v_mul_f32 v33, v129, v13
    v_mul_f32 v34, v130, v13
    v_mul_f32 v35, v131, v13
    v_mul_f32 v36, v132, v13
    v_mul_f32 v37, v133, v13
    v_mul_f32 v38, v134, v13
    v_mul_f32 v39, v135, v13
    v_mul_f32 v40, v136, v13
    v_mul_f32 v41, v137, v13
    v_mul_f32 v42, v138, v13
    v_mul_f32 v43, v139, v13
    v_mul_f32 v44, v140, v13
    v_mul_f32 v45, v141, v13
    v_mul_f32 v46, v142, v13
    v_mul_f32 v47, v143, v13
    v_mul_f32 v48, v144, v13
    v_mul_f32 v49, v145, v13
    v_mul_f32 v50, v146, v13
    v_mul_f32 v51, v147, v13
    v_fma_f32 v128, -v32, v12, v128
    v_fma_f32 v129, -v33, v12, v129
    v_fma_f32 v130, -v34, v12, v130
    v_fma_f32 v131, -v35, v12, v131
    v_fma_f32 v132, -v36, v12, v132
    v_fma_f32 v133, -v37, v12, v133
    v_fma_f32 v134, -v38, v12, v134
    v_fma_f32 v135, -v39, v12, v135
    v_fma_f32 v136, -v40, v12, v136
    v_fma_f32 v137, -v41, v12, v137
    v_fma_f32 v138, -v42, v12, v138
    v_fma_f32 v139, -v43, v12, v139
    v_fma_f32 v140, -v44, v12, v140
    v_fma_f32 v141, -v45, v12, v141
    v_fma_f32 v142, -v46, v12, v142
    v_fma_f32 v143, -v47, v12, v143
    v_fma_f32 v144, -v48, v12, v144
    v_fma_f32 v145, -v49, v12, v145
    v_fma_f32 v146, -v50, v12, v146
    v_fma_f32 v147, -v51, v12, v147
    v_fmac_f32 v32, v128, v13
    v_fmac_f32 v33, v129, v13
    v_fmac_f32 v34, v130, v13
    v_fmac_f32 v35, v131, v13
    v_fmac_f32 v36, v132, v13
    v_fmac_f32 v37, v133, v13
    v_fmac_f32 v38, v134, v13
    v_fmac_f32 v39, v135, v13
    v_fmac_f32 v40, v136, v13
    v_fmac_f32 v41, v137, v13
    v_fmac_f32 v42, v138, v13
    v_fmac_f32 v43, v139, v13
    v_fmac_f32 v44, v140, v13
    v_fmac_f32 v45, v141, v13
    v_fmac_f32 v46, v142, v13
    v_fmac_f32 v47, v143, v13
    v_fmac_f32 v48, v144, v13
    v_fmac_f32 v49, v145, v13
    v_fmac_f32 v50, v146, v13
    v_fmac_f32 v51, v147, v13
    v_cvt_pk_bf16_f32 v16, v32, v33
    v_cvt_pk_bf16_f32 v17, v34, v35
    v_cvt_pk_bf16_f32 v18, v36, v37
    v_cvt_pk_bf16_f32 v19, v38, v39
    v_cvt_pk_bf16_f32 v20, v40, v41
    v_cvt_pk_bf16_f32 v21, v42, v43
    v_cvt_pk_bf16_f32 v22, v44, v45
    v_cvt_pk_bf16_f32 v23, v46, v47
    v_cvt_pk_bf16_f32 v24, v48, v49
    v_cvt_pk_bf16_f32 v25, v50, v51
    ds_write_b64 v59, v[16:17] offset:11072
    ds_write_b64 v59, v[18:19] offset:11080
    ds_write_b64 v59, v[20:21] offset:11088
    ds_write_b64 v59, v[22:23] offset:11096
    ds_write_b64 v59, v[24:25] offset:11104
    v_mul_u32_u24 v60, 20, v62
    s_lshl_b32 s34, s69, 1
    v_add_u32 v2, s34, v60
    ds_read_b32 v112, v2 offset:11072
    ds_read_b32 v113, v2 offset:11076
    ds_read_b32 v114, v2 offset:11080
    ds_read_b32 v115, v2 offset:11084
    ds_read_b32 v116, v2 offset:11088
    ds_read_b32 v117, v2 offset:12352
    ds_read_b32 v118, v2 offset:12356
    ds_read_b32 v119, v2 offset:12360
    ds_read_b32 v120, v2 offset:12364
    ds_read_b32 v121, v2 offset:12368
    v_mov_b32 v32, 0
    v_mov_b32 v33, 0
    v_mov_b32 v34, 0
    v_mov_b32 v35, 0
    v_mov_b32 v36, 0
    v_mov_b32 v37, 0
    v_mov_b32 v38, 0
    v_mov_b32 v39, 0
    v_mov_b32 v40, 0
    v_mov_b32 v41, 0
    v_mov_b32 v42, 0
    v_mov_b32 v43, 0
    v_mov_b32 v44, 0
    v_mov_b32 v45, 0
    v_mov_b32 v46, 0
    v_mov_b32 v47, 0
    s_waitcnt vmcnt(8)
    v_perm_b32 v104, v68, v64, s82
    v_perm_b32 v105, v68, v64, s83
    v_perm_b32 v106, v69, v65, s82
    v_perm_b32 v107, v69, v65, s83
    v_perm_b32 v108, v70, v66, s82
    v_perm_b32 v109, v70, v66, s83
    v_perm_b32 v110, v71, v67, s82
    v_perm_b32 v111, v71, v67, s83
    s_waitcnt lgkmcnt(0)
    v_dot2c_f32_bf16 v32, v112, v104
    v_dot2c_f32_bf16 v33, v112, v105
    v_dot2c_f32_bf16 v34, v112, v106
    v_dot2c_f32_bf16 v35, v112, v107
    v_dot2c_f32_bf16 v36, v112, v108
    v_dot2c_f32_bf16 v37, v112, v109
    v_dot2c_f32_bf16 v38, v112, v110
    v_dot2c_f32_bf16 v39, v112, v111
    v_dot2c_f32_bf16 v40, v117, v104
    v_dot2c_f32_bf16 v41, v117, v105
    v_dot2c_f32_bf16 v42, v117, v106
    v_dot2c_f32_bf16 v43, v117, v107
    v_dot2c_f32_bf16 v44, v117, v108
    v_dot2c_f32_bf16 v45, v117, v109
    v_dot2c_f32_bf16 v46, v117, v110
    v_dot2c_f32_bf16 v47, v117, v111
    s_waitcnt vmcnt(6)
    v_perm_b32 v104, v76, v72, s82
    v_perm_b32 v105, v76, v72, s83
    v_perm_b32 v106, v77, v73, s82
    v_perm_b32 v107, v77, v73, s83
    v_perm_b32 v108, v78, v74, s82
    v_perm_b32 v109, v78, v74, s83
    v_perm_b32 v110, v79, v75, s82
    v_perm_b32 v111, v79, v75, s83
    v_dot2c_f32_bf16 v32, v113, v104
    v_dot2c_f32_bf16 v33, v113, v105
    v_dot2c_f32_bf16 v34, v113, v106
    v_dot2c_f32_bf16 v35, v113, v107
    v_dot2c_f32_bf16 v36, v113, v108
    v_dot2c_f32_bf16 v37, v113, v109
    v_dot2c_f32_bf16 v38, v113, v110
    v_dot2c_f32_bf16 v39, v113, v111
    v_dot2c_f32_bf16 v40, v118, v104
    v_dot2c_f32_bf16 v41, v118, v105
    v_dot2c_f32_bf16 v42, v118, v106
    v_dot2c_f32_bf16 v43, v118, v107
    v_dot2c_f32_bf16 v44, v118, v108
    v_dot2c_f32_bf16 v45, v118, v109
    v_dot2c_f32_bf16 v46, v118, v110
    v_dot2c_f32_bf16 v47, v118, v111
    s_waitcnt vmcnt(4)
    v_perm_b32 v104, v84, v80, s82
    v_perm_b32 v105, v84, v80, s83
    v_perm_b32 v106, v85, v81, s82
    v_perm_b32 v107, v85, v81, s83
    v_perm_b32 v108, v86, v82, s82
    v_perm_b32 v109, v86, v82, s83
    v_perm_b32 v110, v87, v83, s82
    v_perm_b32 v111, v87, v83, s83
    v_dot2c_f32_bf16 v32, v114, v104
    v_dot2c_f32_bf16 v33, v114, v105
    v_dot2c_f32_bf16 v34, v114, v106
    v_dot2c_f32_bf16 v35, v114, v107
    v_dot2c_f32_bf16 v36, v114, v108
    v_dot2c_f32_bf16 v37, v114, v109
    v_dot2c_f32_bf16 v38, v114, v110
    v_dot2c_f32_bf16 v39, v114, v111
    v_dot2c_f32_bf16 v40, v119, v104
    v_dot2c_f32_bf16 v41, v119, v105
    v_dot2c_f32_bf16 v42, v119, v106
    v_dot2c_f32_bf16 v43, v119, v107
    v_dot2c_f32_bf16 v44, v119, v108
    v_dot2c_f32_bf16 v45, v119, v109
    v_dot2c_f32_bf16 v46, v119, v110
    v_dot2c_f32_bf16 v47, v119, v111
    s_waitcnt vmcnt(2)
    v_perm_b32 v104, v92, v88, s82
    v_perm_b32 v105, v92, v88, s83
    v_perm_b32 v106, v93, v89, s82
    v_perm_b32 v107, v93, v89, s83
    v_perm_b32 v108, v94, v90, s82
    v_perm_b32 v109, v94, v90, s83
    v_perm_b32 v110, v95, v91, s82
    v_perm_b32 v111, v95, v91, s83
    v_dot2c_f32_bf16 v32, v115, v104
    v_dot2c_f32_bf16 v33, v115, v105
    v_dot2c_f32_bf16 v34, v115, v106
    v_dot2c_f32_bf16 v35, v115, v107
    v_dot2c_f32_bf16 v36, v115, v108
    v_dot2c_f32_bf16 v37, v115, v109
    v_dot2c_f32_bf16 v38, v115, v110
    v_dot2c_f32_bf16 v39, v115, v111
    v_dot2c_f32_bf16 v40, v120, v104
    v_dot2c_f32_bf16 v41, v120, v105
    v_dot2c_f32_bf16 v42, v120, v106
    v_dot2c_f32_bf16 v43, v120, v107
    v_dot2c_f32_bf16 v44, v120, v108
    v_dot2c_f32_bf16 v45, v120, v109
    v_dot2c_f32_bf16 v46, v120, v110
    v_dot2c_f32_bf16 v47, v120, v111
    s_waitcnt vmcnt(0)
    v_perm_b32 v104, v100, v96, s82
    v_perm_b32 v105, v100, v96, s83
    v_perm_b32 v106, v101, v97, s82
    v_perm_b32 v107, v101, v97, s83
    v_perm_b32 v108, v102, v98, s82
    v_perm_b32 v109, v102, v98, s83
    v_perm_b32 v110, v103, v99, s82
    v_perm_b32 v111, v103, v99, s83
    v_dot2c_f32_bf16 v32, v116, v104
    v_dot2c_f32_bf16 v33, v116, v105
    v_dot2c_f32_bf16 v34, v116, v106
    v_dot2c_f32_bf16 v35, v116, v107
    v_dot2c_f32_bf16 v36, v116, v108
    v_dot2c_f32_bf16 v37, v116, v109
    v_dot2c_f32_bf16 v38, v116, v110
    v_dot2c_f32_bf16 v39, v116, v111
    v_dot2c_f32_bf16 v40, v121, v104
    v_dot2c_f32_bf16 v41, v121, v105
    v_dot2c_f32_bf16 v42, v121, v106
    v_dot2c_f32_bf16 v43, v121, v107
    v_dot2c_f32_bf16 v44, v121, v108
    v_dot2c_f32_bf16 v45, v121, v109
    v_dot2c_f32_bf16 v46, v121, v110
    v_dot2c_f32_bf16 v47, v121, v111
    v_permlane32_swap_b32 v32, v36
    v_permlane32_swap_b32 v33, v37
    v_permlane32_swap_b32 v34, v38
    v_permlane32_swap_b32 v35, v39
    v_add_f32 v32, v32, v36
    v_add_f32 v33, v33, v37
    v_add_f32 v34, v34, v38
    v_add_f32 v35, v35, v39
    s_nop 0
    v_permlane16_swap_b32 v32, v34
    v_permlane16_swap_b32 v33, v35
    v_add_f32 v32, v32, v34
    v_add_f32 v33, v33, v35
    s_nop 0
    v_add_f32_dpp v34, v32, v32 row_ror:8 row_mask:0xf bank_mask:0x3
    v_add_f32_dpp v35, v33, v33 row_ror:8 row_mask:0xf bank_mask:0xc
    v_cndmask_b32 v32, v34, v35, s[78:79]
    v_permlane32_swap_b32 v40, v44
    v_permlane32_swap_b32 v41, v45
    v_permlane32_swap_b32 v42, v46
    v_permlane32_swap_b32 v43, v47
    v_add_f32 v40, v40, v44
    v_add_f32 v41, v41, v45
    v_add_f32 v42, v42, v46
    v_add_f32 v43, v43, v47
    s_nop 0
    v_permlane16_swap_b32 v40, v42
    v_permlane16_swap_b32 v41, v43
    v_add_f32 v40, v40, v42
    v_add_f32 v41, v41, v43
    s_nop 0
    v_add_f32_dpp v42, v40, v40 row_ror:8 row_mask:0xf bank_mask:0x3
    v_add_f32_dpp v43, v41, v41 row_ror:8 row_mask:0xf bank_mask:0xc
    v_cndmask_b32 v40, v42, v43, s[78:79]
    v_lshlrev_b32 v55, 2, v62
    v_lshl_add_u32 v55, v63, 5, v55
    s_lshl_b32 s34, s7, 9
    v_add_u32 v2, s34, v55
    v_mov_b32 v3, 11024
    ds_write_b32 v2, v32 offset:0
    ds_write_b32 v2, v40 offset:256
    s_mov_b64 exec, 1
    ds_add_u32 v3, v58
    s_mov_b64 exec, -1
    s_cmp_eq_u32 s3, 7
    s_cbranch_scc1 L_qx
    s_cmp_eq_u32 s3, 6
    s_cbranch_scc1 L_gate
L_qw2:
    s_nop 4
    s_sub_u32 s75, s75, 1
    s_cbranch_scc1 L_end
    s_sleep 4
    ds_read_b32 v4, v58 offset:11019
    s_waitcnt lgkmcnt(0)
    v_readfirstlane_b32 s34, v4
    s_nop 0
    s_cmp_eq_u32 s34, 0
    s_cbranch_scc1 L_qw2
    s_cmp_eq_u32 s3, 4
    s_cbranch_scc1 L_ffn
    s_sub_u32 s18, s2, 160
    s_cmp_lt_u32 s18, 32
    s_cbranch_scc0 L_gate
    s_add_u32 s18, s18, 256
    s_and_b32 s71, s18, 1
    s_mul_i32 s71, s71, 320
    s_sub_u32 s34, s18, 192
    s_lshr_b32 s35, s34, 2
    s_lshr_b32 s70, s18, 1
    s_cmp_lt_u32 s18, 192
    s_cselect_b32 s70, s70, s35
    s_cselect_b32 s77, 4, 1
    s_mul_i32 s77, s77, 3072
    s_mul_i32 s54, s77, 640
    s_lshl_b32 s70, s70, 7
    s_bitcmp1_b32 s18, 1
    s_cselect_b32 s52, s24, s22
    s_cselect_b32 s53, s25, s23
    s_cmp_lt_u32 s18, 192
    s_cselect_b32 s52, s14, s52
    s_cselect_b32 s53, s15, s53
    v_mul_u32_u24 v61, 30720, v62
    v_lshl_add_u32 v61, v63, 4, v61
    s_mov_b32 s19, 0
    v_mov_b32 v32, 0
    v_mov_b32 v33, 0
    v_mov_b32 v34, 0
    v_mov_b32 v35, 0
    v_mov_b32 v36, 0
    v_mov_b32 v37, 0
    v_mov_b32 v38, 0
    v_mov_b32 v39, 0
    v_mov_b32 v40, 0
    v_mov_b32 v41, 0
    v_mov_b32 v42, 0
    v_mov_b32 v43, 0
    v_mov_b32 v44, 0
    v_mov_b32 v45, 0
    v_mov_b32 v46, 0
    v_mov_b32 v47, 0
L_xloop:
    s_nop 4
    s_mul_i32 s74, s71, 3072
    s_add_u32 s74, s74, s70
    s_lshl_b32 s34, s71, 1
    v_add_u32 v2, s34, v60
    ds_read_b32 v112, v2 offset:11072
    ds_read_b32 v113, v2 offset:11076
    ds_read_b32 v114, v2 offset:11080
    ds_read_b32 v115, v2 offset:11084
    ds_read_b32 v116, v2 offset:11088
    ds_read_b32 v117, v2 offset:12352
    ds_read_b32 v118, v2 offset:12356
    ds_read_b32 v119, v2 offset:12360
    ds_read_b32 v120, v2 offset:12364
    ds_read_b32 v121, v2 offset:12368
    buffer_load_dwordx4 v[64:67], v61, s[52:55], s74 offen nt
    s_add_u32 s74, s74, 3072
    buffer_load_dwordx4 v[68:71], v61, s[52:55], s74 offen nt
    s_add_u32 s74, s74, 3072
    buffer_load_dwordx4 v[72:75], v61, s[52:55], s74 offen nt
    s_add_u32 s74, s74, 3072
    buffer_load_dwordx4 v[76:79], v61, s[52:55], s74 offen nt
    s_add_u32 s74, s74, 3072
    s_waitcnt vmcnt(3)
    buffer_load_dwordx4 v[80:83], v61, s[52:55], s74 offen nt
    s_add_u32 s74, s74, 3072
    s_waitcnt vmcnt(3)
    buffer_load_dwordx4 v[84:87], v61, s[52:55], s74 offen nt
    s_add_u32 s74, s74, 3072
    s_waitcnt vmcnt(3)
    buffer_load_dwordx4 v[88:91], v61, s[52:55], s74 offen nt
    s_add_u32 s74, s74, 3072
    s_waitcnt vmcnt(3)
    buffer_load_dwordx4 v[92:95], v61, s[52:55], s74 offen nt
    s_add_u32 s74, s74, 3072
    s_waitcnt vmcnt(3)
    buffer_load_dwordx4 v[96:99], v61, s[52:55], s74 offen nt
    s_add_u32 s74, s74, 3072
    s_waitcnt vmcnt(3)
    buffer_load_dwordx4 v[100:103], v61, s[52:55], s74 offen nt
    s_waitcnt vmcnt(8)
    v_perm_b32 v104, v68, v64, s82
    v_perm_b32 v105, v68, v64, s83
    v_perm_b32 v106, v69, v65, s82
    v_perm_b32 v107, v69, v65, s83
    v_perm_b32 v108, v70, v66, s82
    v_perm_b32 v109, v70, v66, s83
    v_perm_b32 v110, v71, v67, s82
    v_perm_b32 v111, v71, v67, s83
    s_waitcnt lgkmcnt(0)
    v_dot2c_f32_bf16 v32, v112, v104
    v_dot2c_f32_bf16 v33, v112, v105
    v_dot2c_f32_bf16 v34, v112, v106
    v_dot2c_f32_bf16 v35, v112, v107
    v_dot2c_f32_bf16 v36, v112, v108
    v_dot2c_f32_bf16 v37, v112, v109
    v_dot2c_f32_bf16 v38, v112, v110
    v_dot2c_f32_bf16 v39, v112, v111
    v_dot2c_f32_bf16 v40, v117, v104
    v_dot2c_f32_bf16 v41, v117, v105
    v_dot2c_f32_bf16 v42, v117, v106
    v_dot2c_f32_bf16 v43, v117, v107
    v_dot2c_f32_bf16 v44, v117, v108
    v_dot2c_f32_bf16 v45, v117, v109
    v_dot2c_f32_bf16 v46, v117, v110
    v_dot2c_f32_bf16 v47, v117, v111
    s_waitcnt vmcnt(6)
    v_perm_b32 v104, v76, v72, s82
    v_perm_b32 v105, v76, v72, s83
    v_perm_b32 v106, v77, v73, s82
    v_perm_b32 v107, v77, v73, s83
    v_perm_b32 v108, v78, v74, s82
    v_perm_b32 v109, v78, v74, s83
    v_perm_b32 v110, v79, v75, s82
    v_perm_b32 v111, v79, v75, s83
    v_dot2c_f32_bf16 v32, v113, v104
    v_dot2c_f32_bf16 v33, v113, v105
    v_dot2c_f32_bf16 v34, v113, v106
    v_dot2c_f32_bf16 v35, v113, v107
    v_dot2c_f32_bf16 v36, v113, v108
    v_dot2c_f32_bf16 v37, v113, v109
    v_dot2c_f32_bf16 v38, v113, v110
    v_dot2c_f32_bf16 v39, v113, v111
    v_dot2c_f32_bf16 v40, v118, v104
    v_dot2c_f32_bf16 v41, v118, v105
    v_dot2c_f32_bf16 v42, v118, v106
    v_dot2c_f32_bf16 v43, v118, v107
    v_dot2c_f32_bf16 v44, v118, v108
    v_dot2c_f32_bf16 v45, v118, v109
    v_dot2c_f32_bf16 v46, v118, v110
    v_dot2c_f32_bf16 v47, v118, v111
    s_waitcnt vmcnt(4)
    v_perm_b32 v104, v84, v80, s82
    v_perm_b32 v105, v84, v80, s83
    v_perm_b32 v106, v85, v81, s82
    v_perm_b32 v107, v85, v81, s83
    v_perm_b32 v108, v86, v82, s82
    v_perm_b32 v109, v86, v82, s83
    v_perm_b32 v110, v87, v83, s82
    v_perm_b32 v111, v87, v83, s83
    v_dot2c_f32_bf16 v32, v114, v104
    v_dot2c_f32_bf16 v33, v114, v105
    v_dot2c_f32_bf16 v34, v114, v106
    v_dot2c_f32_bf16 v35, v114, v107
    v_dot2c_f32_bf16 v36, v114, v108
    v_dot2c_f32_bf16 v37, v114, v109
    v_dot2c_f32_bf16 v38, v114, v110
    v_dot2c_f32_bf16 v39, v114, v111
    v_dot2c_f32_bf16 v40, v119, v104
    v_dot2c_f32_bf16 v41, v119, v105
    v_dot2c_f32_bf16 v42, v119, v106
    v_dot2c_f32_bf16 v43, v119, v107
    v_dot2c_f32_bf16 v44, v119, v108
    v_dot2c_f32_bf16 v45, v119, v109
    v_dot2c_f32_bf16 v46, v119, v110
    v_dot2c_f32_bf16 v47, v119, v111
    s_waitcnt vmcnt(2)
    v_perm_b32 v104, v92, v88, s82
    v_perm_b32 v105, v92, v88, s83
    v_perm_b32 v106, v93, v89, s82
    v_perm_b32 v107, v93, v89, s83
    v_perm_b32 v108, v94, v90, s82
    v_perm_b32 v109, v94, v90, s83
    v_perm_b32 v110, v95, v91, s82
    v_perm_b32 v111, v95, v91, s83
    v_dot2c_f32_bf16 v32, v115, v104
    v_dot2c_f32_bf16 v33, v115, v105
    v_dot2c_f32_bf16 v34, v115, v106
    v_dot2c_f32_bf16 v35, v115, v107
    v_dot2c_f32_bf16 v36, v115, v108
    v_dot2c_f32_bf16 v37, v115, v109
    v_dot2c_f32_bf16 v38, v115, v110
    v_dot2c_f32_bf16 v39, v115, v111
    v_dot2c_f32_bf16 v40, v120, v104
    v_dot2c_f32_bf16 v41, v120, v105
    v_dot2c_f32_bf16 v42, v120, v106
    v_dot2c_f32_bf16 v43, v120, v107
    v_dot2c_f32_bf16 v44, v120, v108
    v_dot2c_f32_bf16 v45, v120, v109
    v_dot2c_f32_bf16 v46, v120, v110
    v_dot2c_f32_bf16 v47, v120, v111
    s_waitcnt vmcnt(0)
    v_perm_b32 v104, v100, v96, s82
    v_perm_b32 v105, v100, v96, s83
    v_perm_b32 v106, v101, v97, s82
    v_perm_b32 v107, v101, v97, s83
    v_perm_b32 v108, v102, v98, s82
    v_perm_b32 v109, v102, v98, s83
    v_perm_b32 v110, v103, v99, s82
    v_perm_b32 v111, v103, v99, s83
    v_dot2c_f32_bf16 v32, v116, v104
    v_dot2c_f32_bf16 v33, v116, v105
    v_dot2c_f32_bf16 v34, v116, v106
    v_dot2c_f32_bf16 v35, v116, v107
    v_dot2c_f32_bf16 v36, v116, v108
    v_dot2c_f32_bf16 v37, v116, v109
    v_dot2c_f32_bf16 v38, v116, v110
    v_dot2c_f32_bf16 v39, v116, v111
    v_dot2c_f32_bf16 v40, v121, v104
    v_dot2c_f32_bf16 v41, v121, v105
    v_dot2c_f32_bf16 v42, v121, v106
    v_dot2c_f32_bf16 v43, v121, v107
    v_dot2c_f32_bf16 v44, v121, v108
    v_dot2c_f32_bf16 v45, v121, v109
    v_dot2c_f32_bf16 v46, v121, v110
    v_dot2c_f32_bf16 v47, v121, v111
    s_add_u32 s71, s71, 80
    s_add_u32 s19, s19, 1
    s_cmp_lt_u32 s19, 4
    s_cbranch_scc1 L_xloop
    v_permlane32_swap_b32 v32, v36
    v_permlane32_swap_b32 v33, v37
    v_permlane32_swap_b32 v34, v38
    v_permlane32_swap_b32 v35, v39
    v_add_f32 v32, v32, v36
    v_add_f32 v33, v33, v37
    v_add_f32 v34, v34, v38
    v_add_f32 v35, v35, v39
    s_nop 0
    v_permlane16_swap_b32 v32, v34
    v_permlane16_swap_b32 v33, v35
    v_add_f32 v32, v32, v34
    v_add_f32 v33, v33, v35
    s_nop 0
    v_add_f32_dpp v34, v32, v32 row_ror:8 row_mask:0xf bank_mask:0x3
    v_add_f32_dpp v35, v33, v33 row_ror:8 row_mask:0xf bank_mask:0xc
    v_cndmask_b32 v32, v34, v35, s[78:79]
    v_permlane32_swap_b32 v40, v44
    v_permlane32_swap_b32 v41, v45
    v_permlane32_swap_b32 v42, v46
    v_permlane32_swap_b32 v43, v47
    v_add_f32 v40, v40, v44
    v_add_f32 v41, v41, v45
    v_add_f32 v42, v42, v46
    v_add_f32 v43, v43, v47
    s_nop 0
    v_permlane16_swap_b32 v40, v42
    v_permlane16_swap_b32 v41, v43
    v_add_f32 v40, v40, v42
    v_add_f32 v41, v41, v43
    s_nop 0
    v_add_f32_dpp v42, v40, v40 row_ror:8 row_mask:0xf bank_mask:0x3
    v_add_f32_dpp v43, v41, v41 row_ror:8 row_mask:0xf bank_mask:0xc
    v_cndmask_b32 v40, v42, v43, s[78:79]
    s_lshl_b32 s34, s18, 9
    buffer_store_dword v32, v55, s[44:47], s34 offen sc1
    buffer_store_dword v40, v55, s[44:47], s34 offen offset:256 sc1
    s_branch L_gate
L_qx:
    v_lshlrev_b32 v2, 3, v0
    s_mul_i32 s19, s4, 3072
    s_add_u32 s80, s32, s19
    s_addc_u32 s81, s33, 0
    s_lshl_b32 s34, s4, 10
    s_add_u32 s34, s34, 262144
    s_add_u32 s26, s32, s34
    s_addc_u32 s27, s33, 0
    s_mul_i32 s34, s4, 768
    s_add_u32 s34, s34, 262144
    s_add_u32 s28, s32, s34
    s_addc_u32 s29, s33, 0
    v_lshrrev_b32 v5, 4, v0
    v_lshlrev_b32 v5, 10, v5
    v_and_b32 v6, 15, v0
    v_lshl_add_u32 v5, v6, 4, v5
L_pwait:
    s_nop 4
    s_sub_u32 s75, s75, 1
    s_cbranch_scc1 L_end
    ds_read_b32 v4, v3
    s_waitcnt lgkmcnt(0)
    v_readfirstlane_b32 s34, v4
    s_nop 0
    s_cmp_eq_u32 s34, 5
    s_cbranch_scc0 L_pwait
    ds_read_b64 v[64:65], v2 offset:0
    ds_read_b64 v[66:67], v2 offset:512
    ds_read_b64 v[68:69], v2 offset:1024
    ds_read_b64 v[70:71], v2 offset:1536
    ds_read_b64 v[6:7], v3 offset:8
    s_lshl_b32 s34, s2, 9
    s_waitcnt lgkmcnt(0)
    v_add_f32 v64, v64, v66
    v_add_f32 v65, v65, v67
    v_add_f32 v68, v68, v70
    v_add_f32 v69, v69, v71
    v_add_f32 v64, v64, v68
    v_add_f32 v65, v65, v69
    buffer_store_dwordx2 v[64:65], v2, s[44:47], s34 offen sc1
    v_readfirstlane_b32 s24, v6
    v_readfirstlane_b32 s25, v7
    s_mov_b32 exec_hi, 0xffff
L_qpoll:
    s_nop 4
    s_sub_u32 s75, s75, 1
    s_cbranch_scc1 L_end
    s_load_dwordx2 s[8:9], s[28:29], 0 glc
    s_load_dwordx2 s[10:11], s[28:29], 128 glc
    s_load_dwordx2 s[12:13], s[28:29], 256 glc
    s_load_dwordx2 s[14:15], s[28:29], 384 glc
    s_load_dwordx2 s[16:17], s[28:29], 512 glc
    s_load_dwordx2 s[20:21], s[28:29], 640 glc
    s_waitcnt lgkmcnt(0)
    s_xor_b64 s[8:9], s[8:9], s[24:25]
    s_xor_b64 s[10:11], s[10:11], s[24:25]
    s_xor_b64 s[12:13], s[12:13], s[24:25]
    s_xor_b64 s[14:15], s[14:15], s[24:25]
    s_xor_b64 s[16:17], s[16:17], s[24:25]
    s_xor_b64 s[20:21], s[20:21], s[24:25]
    s_or_b64 s[8:9], s[8:9], s[10:11]
    s_or_b64 s[8:9], s[8:9], s[12:13]
    s_or_b64 s[8:9], s[8:9], s[14:15]
    s_or_b64 s[8:9], s[8:9], s[16:17]
    s_or_b64 s[8:9], s[8:9], s[20:21]
    s_cbranch_scc1 L_qpoll
    s_branch L_tpoll
L_tretry:
    s_sleep 8
L_tpoll:
    s_nop 4
    s_sub_u32 s75, s75, 1
    s_cbranch_scc1 L_end
    s_load_dword s8, s[80:81], 508 glc
    s_load_dword s9, s[80:81], 1020 glc
    s_load_dword s10, s[80:81], 1532 glc
    s_load_dword s11, s[80:81], 2044 glc
    s_load_dword s12, s[80:81], 2556 glc
    s_load_dword s13, s[80:81], 3068 glc
    s_waitcnt lgkmcnt(0)
    s_max_u32 s8, s8, s9
    s_max_u32 s8, s8, s10
    s_max_u32 s8, s8, s11
    s_max_u32 s8, s8, s12
    s_max_u32 s8, s8, s13
    s_cmp_eq_u32 s8, -1
    s_cbranch_scc1 L_tretry
    buffer_load_dwordx4 v[96:99], v5, s[44:47], s19 offen offset:0 sc1
    buffer_load_dwordx4 v[100:103], v5, s[44:47], s19 offen offset:256 sc1
    buffer_load_dwordx4 v[104:107], v5, s[44:47], s19 offen offset:512 sc1
    buffer_load_dwordx4 v[108:111], v5, s[44:47], s19 offen offset:768 sc1
L_gpoll:
    s_load_dwordx2 s[8:9], s[26:27], 0 glc
    s_load_dwordx2 s[10:11], s[26:27], 128 glc
    s_load_dwordx2 s[12:13], s[26:27], 256 glc
    s_load_dwordx2 s[14:15], s[26:27], 384 glc
    s_load_dwordx2 s[16:17], s[26:27], 512 glc
    s_load_dwordx2 s[20:21], s[26:27], 640 glc
    s_load_dwordx2 s[22:23], s[26:27], 768 glc
    s_load_dwordx2 s[68:69], s[26:27], 896 glc
    s_waitcnt lgkmcnt(0)
    s_xor_b64 s[8:9], s[8:9], s[24:25]
    s_xor_b64 s[10:11], s[10:11], s[24:25]
    s_xor_b64 s[12:13], s[12:13], s[24:25]
    s_xor_b64 s[14:15], s[14:15], s[24:25]
    s_xor_b64 s[16:17], s[16:17], s[24:25]
    s_xor_b64 s[20:21], s[20:21], s[24:25]
    s_xor_b64 s[22:23], s[22:23], s[24:25]
    s_xor_b64 s[68:69], s[68:69], s[24:25]
    s_or_b64 s[8:9], s[8:9], s[10:11]
    s_or_b64 s[8:9], s[8:9], s[12:13]
    s_or_b64 s[8:9], s[8:9], s[14:15]
    s_or_b64 s[8:9], s[8:9], s[16:17]
    s_or_b64 s[8:9], s[8:9], s[20:21]
    s_or_b64 s[8:9], s[8:9], s[22:23]
    s_or_b64 s[8:9], s[8:9], s[68:69]
    s_cbranch_scc1 L_tretry
    s_waitcnt vmcnt(0)
    v_max_u32 v12, v96, v97
    v_max_u32 v13, v98, v99
    v_max3_u32 v12, v12, v100, v101
    v_max3_u32 v13, v13, v102, v103
    v_max3_u32 v12, v12, v104, v105
    v_max3_u32 v13, v13, v106, v107
    v_max3_u32 v12, v12, v108, v109
    v_max3_u32 v13, v13, v110, v111
    v_max_u32 v12, v12, v13
    v_cmp_eq_u32 vcc, -1, v12
    s_cbranch_vccnz L_tretry
    v_add_f32 v96, v96, v104
    v_add_f32 v97, v97, v105
    v_add_f32 v98, v98, v106
    v_add_f32 v99, v99, v107
    v_add_f32 v100, v100, v108
    v_add_f32 v101, v101, v109
    v_add_f32 v102, v102, v110
    v_add_f32 v103, v103, v111
    v_cvt_pk_bf16_f32 v96, v96, v97
    v_cvt_pk_bf16_f32 v97, v98, v99
    v_cvt_pk_bf16_f32 v100, v100, v101
    v_cvt_pk_bf16_f32 v101, v102, v103
    ds_write_b64 v2, v[96:97] offset:2048
    ds_write_b64 v2, v[100:101] offset:2432
    s_mov_b32 exec_hi, -1
    ds_write_b32 v58, v58 offset:11019
    s_branch L_gate
L_ffn:
    s_cmp_lt_u32 s2, 240
    s_cbranch_scc0 L_gate
    s_mul_i32 s18, s2, 205
    s_lshr_b32 s18, s18, 11
    s_mul_i32 s19, s18, 10
    s_sub_u32 s19, s2, s19
    ds_read_b64 v[6:7], v3 offset:8
    v_mul_u32_u24 v2, 10240, v62
    v_lshl_add_u32 v2, v63, 4, v2
    s_mul_i32 s34, s18, 81920
    s_lshl_b32 s35, s19, 7
    s_add_u32 s34, s34, s35
    buffer_load_dwordx4 v[96:99], v2, s[56:59], s34 offen nt
    s_add_u32 s34, s34, 1280
    buffer_load_dwordx4 v[100:103], v2, s[56:59], s34 offen nt
    s_add_u32 s34, s34, 1280
    s_waitcnt vmcnt(1)
    buffer_load_dwordx4 v[104:107], v2, s[56:59], s34 offen nt
    s_add_u32 s34, s34, 1280
    s_waitcnt vmcnt(1)
    buffer_load_dwordx4 v[108:111], v2, s[56:59], s34 offen nt
    s_add_u32 s34, s34, 1280
    s_waitcnt vmcnt(1)
    buffer_load_dwordx4 v[112:115], v2, s[56:59], s34 offen nt
    s_add_u32 s34, s34, 1280
    s_waitcnt vmcnt(1)
    buffer_load_dwordx4 v[116:119], v2, s[56:59], s34 offen nt
    s_add_u32 s34, s34, 1280
    s_waitcnt vmcnt(1)
    buffer_load_dwordx4 v[120:123], v2, s[56:59], s34 offen nt
    s_add_u32 s34, s34, 1280
    s_waitcnt vmcnt(1)
    buffer_load_dwordx4 v[124:127], v2, s[56:59], s34 offen nt
    s_add_u32 s34, s34, 1280
    s_lshl_b32 s20, s18, 2
    s_add_u32 s20, s20, 192
    s_sub_u32 s21, s20, 96
    s_cmp_lt_u32 s20, 256
    s_cselect_b32 s21, s20, s21
    s_lshl_b32 s21, s21, 7
    s_add_u32 s21, s21, 262144
    s_add_u32 s26, s32, s21
    s_addc_u32 s27, s33, 0
    s_lshl_b32 s20, s20, 9
    v_lshlrev_b32 v4, 2, v0
    s_waitcnt vmcnt(0) lgkmcnt(0)
    v_readfirstlane_b32 s24, v6
    v_readfirstlane_b32 s25, v7
    v_perm_b32 v128, v100, v96, s82
    v_perm_b32 v129, v100, v96, s83
    v_perm_b32 v130, v101, v97, s82
    v_perm_b32 v131, v101, v97, s83
    v_perm_b32 v132, v102, v98, s82
    v_perm_b32 v133, v102, v98, s83
    v_perm_b32 v134, v103, v99, s82
    v_perm_b32 v135, v103, v99, s83
    v_perm_b32 v136, v108, v104, s82
    v_perm_b32 v137, v108, v104, s83
    v_perm_b32 v138, v109, v105, s82
    v_perm_b32 v139, v109, v105, s83
    v_perm_b32 v140, v110, v106, s82
    v_perm_b32 v141, v110, v106, s83
    v_perm_b32 v142, v111, v107, s82
    v_perm_b32 v143, v111, v107, s83
    v_perm_b32 v144, v116, v112, s82
    v_perm_b32 v145, v116, v112, s83
    v_perm_b32 v146, v117, v113, s82
    v_perm_b32 v147, v117, v113, s83
    v_perm_b32 v148, v118, v114, s82
    v_perm_b32 v149, v118, v114, s83
    v_perm_b32 v150, v119, v115, s82
    v_perm_b32 v151, v119, v115, s83
    v_perm_b32 v152, v124, v120, s82
    v_perm_b32 v153, v124, v120, s83
    v_perm_b32 v154, v125, v121, s82
    v_perm_b32 v155, v125, v121, s83
    v_perm_b32 v156, v126, v122, s82
    v_perm_b32 v157, v126, v122, s83
    v_perm_b32 v158, v127, v123, s82
    v_perm_b32 v159, v127, v123, s83
L_fflag:
    s_nop 4
    s_sub_u32 s75, s75, 1
    s_cbranch_scc1 L_end
    s_load_dwordx2 s[8:9], s[26:27], 0 glc
    s_load_dwordx2 s[10:11], s[26:27], 128 glc
    s_load_dwordx2 s[12:13], s[26:27], 256 glc
    s_load_dwordx2 s[14:15], s[26:27], 384 glc
    s_waitcnt lgkmcnt(0)
    s_xor_b64 s[8:9], s[8:9], s[24:25]
    s_xor_b64 s[10:11], s[10:11], s[24:25]
    s_xor_b64 s[12:13], s[12:13], s[24:25]
    s_xor_b64 s[14:15], s[14:15], s[24:25]
    s_or_b64 s[8:9], s[8:9], s[10:11]
    s_or_b64 s[8:9], s[8:9], s[12:13]
    s_or_b64 s[8:9], s[8:9], s[14:15]
    s_cbranch_scc1 L_fflag
    s_branch L_fgath
L_fretry:
    s_sleep 64
L_fgath:
    s_nop 4
    s_sub_u32 s75, s75, 1
    s_cbranch_scc1 L_end
    buffer_load_dword v16, v4, s[44:47], s20 offen offset:0 sc1
    buffer_load_dword v17, v4, s[44:47], s20 offen offset:256 sc1
    buffer_load_dword v18, v4, s[44:47], s20 offen offset:512 sc1
    buffer_load_dword v19, v4, s[44:47], s20 offen offset:768 sc1
    buffer_load_dword v20, v4, s[44:47], s20 offen offset:1024 sc1
    buffer_load_dword v21, v4, s[44:47], s20 offen offset:1280 sc1
    buffer_load_dword v22, v4, s[44:47], s20 offen offset:1536 sc1
    buffer_load_dword v23, v4, s[44:47], s20 offen offset:1792 sc1
    s_waitcnt vmcnt(0)
    v_max3_u32 v12, v16, v17, v18
    v_max3_u32 v13, v19, v20, v21
    v_max3_u32 v12, v12, v22, v23
    v_max_u32 v12, v12, v13
    v_cmp_eq_u32 vcc, -1, v12
    s_cbranch_vccnz L_fretry
    v_add_f32 v16, v16, v18
    v_add_f32 v17, v17, v19
    v_add_f32 v20, v20, v22
    v_add_f32 v21, v21, v23
    v_cvt_pk_bf16_f32 v16, v16, v16
    v_and_b32 v16, 0xffff0000, v16
    v_cvt_pk_bf16_f32 v20, v20, v20
    v_and_b32 v20, 0xffff0000, v20
    v_mul_f32 v13, 0xbfb8aa3b, v16
    v_exp_f32 v13, v13
    s_nop 0
    v_add_f32 v13, 1.0, v13
    v_rcp_f32 v13, v13
    s_nop 0
    v_mul_f32 v13, v16, v13
    v_cvt_pk_bf16_f32 v13, v13, v13
    v_and_b32 v13, 0xffff0000, v13
    v_mul_f32 v16, v13, v20
    s_nop 1
    v_mov_b32_dpp v12, v16 quad_perm:[1,0,3,2] row_mask:0xf bank_mask:0xf
    v_cvt_pk_bf16_f32 v16, v16, v12
    v_cvt_pk_bf16_f32 v17, v17, v17
    v_and_b32 v17, 0xffff0000, v17
    v_cvt_pk_bf16_f32 v21, v21, v21
    v_and_b32 v21, 0xffff0000, v21
    v_mul_f32 v13, 0xbfb8aa3b, v17
    v_exp_f32 v13, v13
    s_nop 0
    v_add_f32 v13, 1.0, v13
    v_rcp_f32 v13, v13
    s_nop 0
    v_mul_f32 v13, v17, v13
    v_cvt_pk_bf16_f32 v13, v13, v13
    v_and_b32 v13, 0xffff0000, v13
    v_mul_f32 v17, v13, v21
    s_nop 1
    v_mov_b32_dpp v12, v17 quad_perm:[1,0,3,2] row_mask:0xf bank_mask:0xf
    v_cvt_pk_bf16_f32 v17, v17, v12
    v_mov_b32_dpp v24, v16 row_newbcast:0 row_mask:0xf bank_mask:0x3
    s_nop 1
    v_mov_b32_dpp v24, v16 row_newbcast:8 row_mask:0xf bank_mask:0xc
    v_mov_b32_dpp v25, v16 row_newbcast:2 row_mask:0xf bank_mask:0x3
    s_nop 1
    v_mov_b32_dpp v25, v16 row_newbcast:10 row_mask:0xf bank_mask:0xc
    v_mov_b32_dpp v26, v16 row_newbcast:4 row_mask:0xf bank_mask:0x3
    s_nop 1
    v_mov_b32_dpp v26, v16 row_newbcast:12 row_mask:0xf bank_mask:0xc
    v_mov_b32_dpp v27, v16 row_newbcast:6 row_mask:0xf bank_mask:0x3
    s_nop 1
    v_mov_b32_dpp v27, v16 row_newbcast:14 row_mask:0xf bank_mask:0xc
    v_mov_b32_dpp v28, v17 row_newbcast:0 row_mask:0xf bank_mask:0x3
    s_nop 1
    v_mov_b32_dpp v28, v17 row_newbcast:8 row_mask:0xf bank_mask:0xc
    v_mov_b32_dpp v29, v17 row_newbcast:2 row_mask:0xf bank_mask:0x3
    s_nop 1
    v_mov_b32_dpp v29, v17 row_newbcast:10 row_mask:0xf bank_mask:0xc
    v_mov_b32_dpp v30, v17 row_newbcast:4 row_mask:0xf bank_mask:0x3
    s_nop 1
    v_mov_b32_dpp v30, v17 row_newbcast:12 row_mask:0xf bank_mask:0xc
    v_mov_b32_dpp v31, v17 row_newbcast:6 row_mask:0xf bank_mask:0x3
    s_nop 1
    v_mov_b32_dpp v31, v17 row_newbcast:14 row_mask:0xf bank_mask:0xc
    v_mov_b32 v32, 0
    v_mov_b32 v33, 0
    v_mov_b32 v34, 0
    v_mov_b32 v35, 0
    v_mov_b32 v36, 0
    v_mov_b32 v37, 0
    v_mov_b32 v38, 0
    v_mov_b32 v39, 0
    v_mov_b32 v40, 0
    v_mov_b32 v41, 0
    v_mov_b32 v42, 0
    v_mov_b32 v43, 0
    v_mov_b32 v44, 0
    v_mov_b32 v45, 0
    v_mov_b32 v46, 0
    v_mov_b32 v47, 0
    v_dot2c_f32_bf16 v32, v24, v128
    v_dot2c_f32_bf16 v33, v24, v129
    v_dot2c_f32_bf16 v34, v24, v130
    v_dot2c_f32_bf16 v35, v24, v131
    v_dot2c_f32_bf16 v36, v24, v132
    v_dot2c_f32_bf16 v37, v24, v133
    v_dot2c_f32_bf16 v38, v24, v134
    v_dot2c_f32_bf16 v39, v24, v135
    v_dot2c_f32_bf16 v40, v28, v128
    v_dot2c_f32_bf16 v41, v28, v129
    v_dot2c_f32_bf16 v42, v28, v130
    v_dot2c_f32_bf16 v43, v28, v131
    v_dot2c_f32_bf16 v44, v28, v132
    v_dot2c_f32_bf16 v45, v28, v133
    v_dot2c_f32_bf16 v46, v28, v134
    v_dot2c_f32_bf16 v47, v28, v135
    v_dot2c_f32_bf16 v32, v25, v136
    v_dot2c_f32_bf16 v33, v25, v137
    v_dot2c_f32_bf16 v34, v25, v138
    v_dot2c_f32_bf16 v35, v25, v139
    v_dot2c_f32_bf16 v36, v25, v140
    v_dot2c_f32_bf16 v37, v25, v141
    v_dot2c_f32_bf16 v38, v25, v142
    v_dot2c_f32_bf16 v39, v25, v143
    v_dot2c_f32_bf16 v40, v29, v136
    v_dot2c_f32_bf16 v41, v29, v137
    v_dot2c_f32_bf16 v42, v29, v138
    v_dot2c_f32_bf16 v43, v29, v139
    v_dot2c_f32_bf16 v44, v29, v140
    v_dot2c_f32_bf16 v45, v29, v141
    v_dot2c_f32_bf16 v46, v29, v142
    v_dot2c_f32_bf16 v47, v29, v143
    v_dot2c_f32_bf16 v32, v26, v144
    v_dot2c_f32_bf16 v33, v26, v145
    v_dot2c_f32_bf16 v34, v26, v146
    v_dot2c_f32_bf16 v35, v26, v147
    v_dot2c_f32_bf16 v36, v26, v148
    v_dot2c_f32_bf16 v37, v26, v149
    v_dot2c_f32_bf16 v38, v26, v150
    v_dot2c_f32_bf16 v39, v26, v151
    v_dot2c_f32_bf16 v40, v30, v144
    v_dot2c_f32_bf16 v41, v30, v145
    v_dot2c_f32_bf16 v42, v30, v146
    v_dot2c_f32_bf16 v43, v30, v147
    v_dot2c_f32_bf16 v44, v30, v148
    v_dot2c_f32_bf16 v45, v30, v149
    v_dot2c_f32_bf16 v46, v30, v150
    v_dot2c_f32_bf16 v47, v30, v151
    v_dot2c_f32_bf16 v32, v27, v152
    v_dot2c_f32_bf16 v33, v27, v153
    v_dot2c_f32_bf16 v34, v27, v154
    v_dot2c_f32_bf16 v35, v27, v155
    v_dot2c_f32_bf16 v36, v27, v156
    v_dot2c_f32_bf16 v37, v27, v157
    v_dot2c_f32_bf16 v38, v27, v158
    v_dot2c_f32_bf16 v39, v27, v159
    v_dot2c_f32_bf16 v40, v31, v152
    v_dot2c_f32_bf16 v41, v31, v153
    v_dot2c_f32_bf16 v42, v31, v154
    v_dot2c_f32_bf16 v43, v31, v155
    v_dot2c_f32_bf16 v44, v31, v156
    v_dot2c_f32_bf16 v45, v31, v157
    v_dot2c_f32_bf16 v46, v31, v158
    v_dot2c_f32_bf16 v47, v31, v159
    v_permlane32_swap_b32 v32, v36
    v_permlane32_swap_b32 v33, v37
    v_permlane32_swap_b32 v34, v38
    v_permlane32_swap_b32 v35, v39
    v_add_f32 v32, v32, v36
    v_add_f32 v33, v33, v37
    v_add_f32 v34, v34, v38
    v_add_f32 v35, v35, v39
    s_nop 0
    v_permlane16_swap_b32 v32, v34
    v_permlane16_swap_b32 v33, v35
    v_add_f32 v32, v32, v34
    v_add_f32 v33, v33, v35
    s_nop 0
    v_add_f32_dpp v34, v32, v32 row_ror:8 row_mask:0xf bank_mask:0x3
    v_add_f32_dpp v35, v33, v33 row_ror:8 row_mask:0xf bank_mask:0xc
    v_cndmask_b32 v32, v34, v35, s[78:79]
    v_permlane32_swap_b32 v40, v44
    v_permlane32_swap_b32 v41, v45
    v_permlane32_swap_b32 v42, v46
    v_permlane32_swap_b32 v43, v47
    v_add_f32 v40, v40, v44
    v_add_f32 v41, v41, v45
    v_add_f32 v42, v42, v46
    v_add_f32 v43, v43, v47
    s_nop 0
    v_permlane16_swap_b32 v40, v42
    v_permlane16_swap_b32 v41, v43
    v_add_f32 v40, v40, v42
    v_add_f32 v41, v41, v43
    s_nop 0
    v_add_f32_dpp v42, v40, v40 row_ror:8 row_mask:0xf bank_mask:0x3
    v_add_f32_dpp v43, v41, v41 row_ror:8 row_mask:0xf bank_mask:0xc
    v_cndmask_b32 v40, v42, v43, s[78:79]
    s_mul_i32 s34, s19, 6144
    s_lshl_b32 s35, s18, 8
    s_add_u32 s34, s34, s35
    s_add_u32 s34, s34, 1572864
    s_add_u32 s35, s34, 61440
    buffer_store_dword v32, v55, s[44:47], s34 offen sc1
    buffer_store_dword v40, v55, s[44:47], s35 offen sc1
    s_branch L_gate
L_flood:
    s_or_b32 s34, s2, s3
    s_cmp_eq_u32 s34, 2
    s_cbranch_scc0 L_nonon
    s_cmp_eq_u32 s2, 0
    s_cbranch_scc0 L_nonon
    s_memrealtime s[80:81]
    v_mov_b32 v2, 0
    s_waitcnt lgkmcnt(0)
    s_or_b32 s80, s80, 1
    s_bitset1_b32 s81, 31
    v_mov_b32 v4, s80
    v_mov_b32 v5, s81
    s_mov_b64 exec, 1
    global_store_dwordx2 v2, v[4:5], s[30:31] sc1
    s_mov_b64 exec, -1
L_nonon:
    s_lshl_b32 s68, s6, 5
    s_add_u32 s68, s68, s4
    s_mul_i32 s68, s68, 3145728
    s_mov_b32 s38, 3145728
    s_mov_b32 s39, 0x20000
    s_lshl_b32 s72, s4, 1
    s_add_u32 s72, s72, s6
    s_lshl_b32 s72, s72, 8
    s_add_u32 s72, s72, 327680
    s_mov_b32 s75, 0x1000000
    s_mov_b32 s46, 1835008
    s_mov_b32 s47, 0x20000
    s_cmp_eq_u32 s3, 1
    s_cbranch_scc0 L_nocpf
    s_getpc_b64 s[80:81]
L_pcref:
    s_sub_u32 s80, s80, L_pcref-recurrent_scan__mha_block_cached__moe_arch_mod__decode_kernel
    s_subb_u32 s81, s81, 0
    s_min_u32 s34, s4, 18
    s_lshl_b32 s34, s34, 10
    v_lshl_add_u32 v2, v0, 4, s34
    global_load_dwordx4 v[16:19], v2, s[80:81]
L_nocpf:
    s_cmp_eq_u32 s3, 0
    s_cbranch_scc0 L_nores0
    v_mov_b32 v27, 1073741824
    v_mov_b32 v28, -1
    v_mov_b32 v29, -1
    v_mov_b32 v30, -1
    v_mov_b32 v31, -1
    s_lshl_b32 s34, s2, 9
    v_lshl_add_u32 v58, v0, 4, s34
    s_sub_u32 s35, s2, 160
    s_cmp_lt_u32 s35, 32
    s_cselect_b32 s35, 48640, 1073741824
    v_add_u32 v2, s35, v58
    v_cmp_gt_u32 vcc, 32, v0
    s_nop 1
    v_cndmask_b32 v58, v2, v58, vcc
    v_lshrrev_b32 v2, 4, v0
    v_and_b32 v3, 15, v0
    v_lshlrev_b32 v3, 4, v3
    v_lshl_add_u32 v59, v2, 11, v3
    v_add_u32 v60, 8192, v59
    v_cndmask_b32 v60, v27, v60, vcc
    v_mul_u32_u24 v4, 61440, v2
    v_add_u32 v4, v4, v3
    v_cndmask_b32 v57, v27, v4, vcc
    s_mul_i32 s70, s4, 12288
    s_lshl_b32 s71, s5, 8
    s_add_u32 s70, s70, s71
    s_add_u32 s70, s70, 393216
    s_lshl_b32 s71, s5, 2
    v_add_u32 v4, s71, v2
    v_mul_u32_u24 v5, 26, v4
    v_lshrrev_b32 v5, 8, v5
    v_mul_u32_u24 v6, 10, v5
    v_sub_u32 v6, v4, v6
    v_mul_u32_u24 v6, 24576, v6
    v_lshl_add_u32 v5, v5, 8, v6
    v_add_u32 v61, v5, v3
    v_cmp_gt_u32 vcc, 30, v4
    s_nop 1
    v_cndmask_b32 v61, v27, v61, vcc
    s_mul_i32 s77, s4, 768
    s_add_u32 s77, s77, 1048576
    s_add_u32 s69, s77, 245760
    s_mul_i32 s34, s2, 205
    s_lshr_b32 s34, s34, 11
    s_mul_i32 s35, s34, 10
    s_sub_u32 s35, s2, s35
    s_mul_i32 s35, s35, 6144
    s_lshl_b32 s34, s34, 8
    s_add_u32 s74, s34, s35
    s_add_u32 s74, s74, 1572864
    s_cmp_lt_u32 s2, 240
    s_cselect_b32 s34, 0, 1073741824
    v_or_b32 v57, s34, v57
    v_lshrrev_b32 v2, 1, v0
    v_lshlrev_b32 v2, 8, v2
    v_and_b32 v3, 1, v0
    v_lshl_add_u32 v26, v3, 4, v2
    v_cmp_gt_u32 vcc, 4, v0
    s_nop 1
    v_cndmask_b32 v26, v27, v26, vcc
    s_lshl_b32 s71, s5, 5
    s_add_u32 s71, s71, s72
    s_waitcnt lgkmcnt(0)
    s_mov_b64 s[44:45], s[32:33]
    buffer_store_dwordx4 v[28:31], v58, s[44:47], 0 offen sc1
    buffer_store_dwordx4 v[28:31], v59, s[44:47], s70 offen sc1
    buffer_store_dwordx4 v[28:31], v60, s[44:47], s70 offen sc1
    buffer_store_dwordx4 v[28:31], v61, s[44:47], s77 offen sc1
    buffer_store_dwordx4 v[28:31], v61, s[44:47], s69 offen sc1
    buffer_store_dwordx4 v[28:31], v57, s[44:47], s74 offen sc1
    buffer_store_dwordx4 v[28:31], v26, s[44:47], s71 offen sc1
L_nores0:
    s_waitcnt lgkmcnt(0)
    s_add_u32 s36, s10, s68
    s_addc_u32 s37, s11, 0
    s_mov_b64 s[44:45], s[32:33]
    s_mov_b64 s[48:49], s[8:9]
    s_mov_b64 s[52:53], s[16:17]
    s_mov_b32 s54, 7864320
    s_add_u32 s40, s12, s68
    s_addc_u32 s41, s13, 0
    s_mov_b32 s42, 3145728
    s_mov_b32 s43, 0x20000
    s_mov_b64 s[56:57], s[26:27]
    s_mov_b32 s58, 1966080
    s_mov_b32 s59, 0x20000
    s_mov_b64 s[60:61], s[20:21]
    s_movk_i32 s62, 1280
    s_mov_b32 s63, 0x20000
    s_mov_b64 s[64:65], s[28:29]
    s_movk_i32 s66, 2560
    s_mov_b32 s67, 0x20000
    s_mov_b32 s78, 0xff00ff00
    s_mov_b32 s79, 0xff00ff00
    s_mov_b32 s82, 0x05040100
    s_mov_b32 s83, 0x07060302
    s_lshl_b32 s73, s5, 2
    s_add_u32 s73, s73, s7
    s_lshl_b32 s73, s73, 3
    s_add_u32 s73, s73, s72
    v_mov_b32 v56, 1073741824
    v_writelane_b32 v56, s73, 0
    s_lshl_b32 s34, s7, 2
    v_mov_b32 v57, s34
    v_mov_b32 v58, 1
    s_mul_i32 s81, s5, 4
    s_mul_i32 s34, s7, 1
    s_add_u32 s81, s81, s34
    v_mov_b32 v64, 0
    s_lshl_b32 s34, s6, 5
    v_mov_b32 v65, s34
    s_mov_b64 vcc, -1
    s_barrier
    s_mov_b32 s80, s81
    s_mul_i32 s76, s80, 3072
    buffer_load_dwordx4 v[76:79], v1, s[36:39], s76 offen offset:0 nt
    buffer_load_dwordx4 v[80:83], v1, s[36:39], s76 offen offset:128 nt
    buffer_load_dwordx4 v[84:87], v1, s[36:39], s76 offen offset:256 nt
    s_add_u32 s80, s80, 3
    s_and_b32 s80, s80, 31
    s_mul_i32 s76, s80, 3072
    s_add_u32 s76, s76, 98304
    buffer_load_dwordx4 v[88:91], v1, s[36:39], s76 offen offset:0 nt
    buffer_load_dwordx4 v[92:95], v1, s[36:39], s76 offen offset:128 nt
    s_cmp_eq_u32 s3, 0
    s_cbranch_scc0 L_pre
    v_mov_b32 v2, 0
    v_lshlrev_b32 v3, 4, v0
    v_mov_b32 v5, 11024
    s_lshl_b32 s35, s2, 7
    s_add_u32 s35, s35, 262144
    global_load_dwordx2 v[28:29], v2, s[30:31] sc1
    s_waitcnt vmcnt(5)
    buffer_load_dwordx4 v[96:99], v1, s[36:39], s76 offen offset:256 nt
    s_waitcnt vmcnt(5)
    s_add_u32 s80, s80, 3
    s_and_b32 s80, s80, 31
    s_mul_i32 s76, s80, 3072
    s_add_u32 s76, s76, 196608
    buffer_load_dwordx4 v[100:103], v1, s[36:39], s76 offen offset:0 nt
    s_waitcnt vmcnt(5)
    buffer_load_dwordx4 v[104:107], v1, s[36:39], s76 offen offset:128 nt
    s_waitcnt vmcnt(5)
    buffer_load_dwordx4 v[108:111], v1, s[36:39], s76 offen offset:256 nt
    s_waitcnt vmcnt(5)
    s_add_u32 s80, s80, 3
    s_and_b32 s80, s80, 31
    s_mul_i32 s76, s80, 3072
    s_add_u32 s76, s76, 294912
    buffer_load_dwordx4 v[112:115], v1, s[36:39], s76 offen offset:0 nt
    s_waitcnt vmcnt(5)
    s_branch L_nchk
L_npoll:
    s_nop 4
    s_sub_u32 s75, s75, 1
    s_cbranch_scc1 L_end
    global_load_dwordx2 v[28:29], v2, s[30:31] sc1
    s_waitcnt vmcnt(0)
L_nchk:
    v_min_u32 v30, v28, v29
    v_cmp_eq_u32 vcc, 0, v30
    s_cbranch_vccnz L_npoll
    v_mov_b32 v30, v28
    v_mov_b32 v31, v29
    s_mov_b64 exec, 0xff
    buffer_store_dwordx4 v[28:31], v3, s[44:47], s35 offen sc1
    s_mov_b64 exec, 1
    ds_write_b64 v5, v[28:29] offset:8
    ds_add_u32 v5, v58
    s_mov_b64 exec, -1
    s_mov_b64 vcc, -1
    s_branch L_pre2
L_gate:
    s_nop 4
    v_mov_b32 v2, 11032
    ds_read_b32 v3, v2
    s_mul_i32 s34, s5, 4
    s_sub_u32 s34, s4, s34
    s_and_b32 s34, s34, 31
    s_lshl_b32 s34, s34, 10
    s_add_u32 s34, s34, 294912
    s_add_u32 s26, s32, s34
    s_addc_u32 s27, s33, 0
    s_lshl_b32 s35, s5, 7
    s_add_u32 s34, s34, s35
    v_lshl_add_u32 v61, v0, 3, s34
    v_mov_b32 v2, 1073741824
    v_cmp_gt_u32 vcc, 16, v0
    s_nop 1
    v_cndmask_b32 v61, v2, v61, vcc
    s_mov_b32 s73, 24
    s_mov_b32 s12, 0
    s_waitcnt lgkmcnt(0)
    v_readfirstlane_b32 s13, v3
L_gwait:
    s_nop 4
    s_sub_u32 s75, s75, 1
    s_cbranch_scc1 L_end
    s_cmp_eq_u32 s3, 7
    s_cbranch_scc0 L_gw2
    v_mov_b32 v2, 0
    ds_read_b128 v[4:7], v2 offset:11056
    s_waitcnt lgkmcnt(0)
    v_add_u32 v4, v4, v5
    v_add3_u32 v4, v4, v6, v7
    s_nop 0
    v_readfirstlane_b32 s35, v4
    s_nop 0
    s_cmp_lt_u32 s35, s73
    s_cbranch_scc1 L_cs1
    s_memrealtime s[80:81]
    s_load_dwordx2 s[8:9], s[26:27], 0 glc
    s_load_dwordx2 s[10:11], s[26:27], 128 glc
    s_load_dwordx2 s[14:15], s[26:27], 256 glc
    s_load_dwordx2 s[16:17], s[26:27], 384 glc
    s_load_dwordx2 s[18:19], s[26:27], 512 glc
    s_load_dwordx2 s[20:21], s[26:27], 640 glc
    s_load_dwordx2 s[22:23], s[26:27], 768 glc
    s_load_dwordx2 s[24:25], s[26:27], 896 glc
    s_xor_b32 s12, s73, s13
    v_mov_b32 v4, s12
    s_waitcnt lgkmcnt(0)
    v_mov_b32 v5, s80
    buffer_store_dwordx2 v[4:5], v61, s[44:47], 0 offen sc1
    s_mov_b32 s34, 0
    s_sub_u32 s9, s80, s9
    s_max_i32 s9, s9, 0
    s_cmp_eq_u32 s8, s12
    s_cselect_b32 s9, s9, 0
    s_add_u32 s34, s34, s9
    s_sub_u32 s11, s80, s11
    s_max_i32 s11, s11, 0
    s_cmp_eq_u32 s10, s12
    s_cselect_b32 s11, s11, 0
    s_add_u32 s34, s34, s11
    s_sub_u32 s15, s80, s15
    s_max_i32 s15, s15, 0
    s_cmp_eq_u32 s14, s12
    s_cselect_b32 s15, s15, 0
    s_add_u32 s34, s34, s15
    s_sub_u32 s17, s80, s17
    s_max_i32 s17, s17, 0
    s_cmp_eq_u32 s16, s12
    s_cselect_b32 s17, s17, 0
    s_add_u32 s34, s34, s17
    s_sub_u32 s19, s80, s19
    s_max_i32 s19, s19, 0
    s_cmp_eq_u32 s18, s12
    s_cselect_b32 s19, s19, 0
    s_add_u32 s34, s34, s19
    s_sub_u32 s21, s80, s21
    s_max_i32 s21, s21, 0
    s_cmp_eq_u32 s20, s12
    s_cselect_b32 s21, s21, 0
    s_add_u32 s34, s34, s21
    s_sub_u32 s23, s80, s23
    s_max_i32 s23, s23, 0
    s_cmp_eq_u32 s22, s12
    s_cselect_b32 s23, s23, 0
    s_add_u32 s34, s34, s23
    s_sub_u32 s25, s80, s25
    s_max_i32 s25, s25, 0
    s_cmp_eq_u32 s24, s12
    s_cselect_b32 s25, s25, 0
    s_add_u32 s34, s34, s25
    s_sub_i32 s34, s34, 200
    s_max_i32 s34, s34, 0
    s_mul_i32 s34, s34, 36
    s_lshr_b32 s34, s34, 10
    s_min_u32 s34, s34, 40
    s_cmp_eq_u32 s34, 0
    s_cselect_b32 s80, 0, 3
    s_add_u32 s34, s34, s80
    s_add_u32 s12, s35, s34
    s_add_u32 s73, s73, 40
L_cs1:
    s_cmp_lt_u32 s35, s12
    s_cselect_b32 s34, 1, 0
    v_mov_b32 v3, s34
    ds_write_b32 v2, v3 offset:11016
L_gw2:
    s_sleep 2
    ds_read_b32 v4, v57 offset:11040
    s_waitcnt lgkmcnt(0)
    v_readfirstlane_b32 s34, v4
    s_nop 0
    s_cmp_eq_u32 s34, 0
    s_cbranch_scc1 L_gwait
    v_mov_b32 v64, 0
    s_lshl_b32 s34, s6, 5
    v_mov_b32 v65, s34
    s_mov_b64 vcc, -1
    ds_write_b32 v58, v64 offset:11015
    s_mul_i32 s81, s5, 4
    s_mul_i32 s34, s7, 1
    s_add_u32 s81, s81, s34
    s_mov_b32 s80, s81
    s_mul_i32 s76, s80, 3072
    buffer_load_dwordx4 v[76:79], v1, s[36:39], s76 offen offset:0 nt
    buffer_load_dwordx4 v[80:83], v1, s[36:39], s76 offen offset:128 nt
    buffer_load_dwordx4 v[84:87], v1, s[36:39], s76 offen offset:256 nt
    s_add_u32 s80, s80, 3
    s_and_b32 s80, s80, 31
    s_mul_i32 s76, s80, 3072
    s_add_u32 s76, s76, 98304
    buffer_load_dwordx4 v[88:91], v1, s[36:39], s76 offen offset:0 nt
    buffer_load_dwordx4 v[92:95], v1, s[36:39], s76 offen offset:128 nt
L_pre:
    s_waitcnt vmcnt(4)
    buffer_load_dwordx4 v[96:99], v1, s[36:39], s76 offen offset:256 nt
    s_waitcnt vmcnt(4)
    s_add_u32 s80, s80, 3
    s_and_b32 s80, s80, 31
    s_mul_i32 s76, s80, 3072
    s_add_u32 s76, s76, 196608
    buffer_load_dwordx4 v[100:103], v1, s[36:39], s76 offen offset:0 nt
    s_waitcnt vmcnt(4)
    buffer_load_dwordx4 v[104:107], v1, s[36:39], s76 offen offset:128 nt
    s_waitcnt vmcnt(4)
    buffer_load_dwordx4 v[108:111], v1, s[36:39], s76 offen offset:256 nt
    s_waitcnt vmcnt(4)
    s_add_u32 s80, s80, 3
    s_and_b32 s80, s80, 31
    s_mul_i32 s76, s80, 3072
    s_add_u32 s76, s76, 294912
    buffer_load_dwordx4 v[112:115], v1, s[36:39], s76 offen offset:0 nt
L_pre2:
    s_waitcnt vmcnt(4)
    buffer_load_dwordx4 v[116:119], v1, s[36:39], s76 offen offset:128 nt
    s_waitcnt vmcnt(4)
    buffer_load_dwordx4 v[120:123], v1, s[36:39], s76 offen offset:256 nt
    s_waitcnt lgkmcnt(0)
    v_cmp_eq_u32 vcc, 0, v64
    v_add_u32 v65, 1, v65
    ds_write_b32 v57, v65 offset:11056
    ds_read_b32 v64, v58 offset:11015
    s_waitcnt vmcnt(6)
    s_cbranch_vccz L_aw1
    s_waitcnt vmcnt(4)
L_aw1:
    s_add_u32 s80, s80, 3
    s_and_b32 s80, s80, 31
    s_mul_i32 s76, s80, 3072
    s_add_u32 s76, s76, 393216
    buffer_load_dwordx4 v[124:127], v1, s[36:39], s76 offen offset:0 nt
    s_waitcnt vmcnt(6)
    s_cbranch_vccz L_aw2
    s_waitcnt vmcnt(4)
L_aw2:
    buffer_load_dwordx4 v[128:131], v1, s[36:39], s76 offen offset:128 nt
    s_waitcnt vmcnt(6)
    s_cbranch_vccz L_aw3
    s_waitcnt vmcnt(4)
L_aw3:
    buffer_load_dwordx4 v[132:135], v1, s[36:39], s76 offen offset:256 nt
    s_waitcnt vmcnt(6)
    s_cbranch_vccz L_aw4
    s_waitcnt vmcnt(4)
L_aw4:
    s_add_u32 s80, s80, 3
    s_and_b32 s80, s80, 31
    s_mul_i32 s76, s80, 3072
    s_add_u32 s76, s76, 491520
    buffer_load_dwordx4 v[136:139], v1, s[36:39], s76 offen offset:0 nt
    s_waitcnt vmcnt(6)
    s_cbranch_vccz L_aw5
    s_waitcnt vmcnt(4)
L_aw5:
    buffer_load_dwordx4 v[140:143], v1, s[36:39], s76 offen offset:128 nt
    s_waitcnt vmcnt(6)
    s_cbranch_vccz L_aw6
    s_waitcnt vmcnt(4)
L_aw6:
    buffer_load_dwordx4 v[144:147], v1, s[36:39], s76 offen offset:256 nt
    s_waitcnt lgkmcnt(0)
    v_cmp_eq_u32 vcc, 0, v64
    v_add_u32 v65, 1, v65
    ds_write_b32 v57, v65 offset:11056
    ds_read_b32 v64, v58 offset:11015
    s_waitcnt vmcnt(6)
    s_cbranch_vccz L_aw7
    s_waitcnt vmcnt(4)
L_aw7:
    s_add_u32 s80, s80, 3
    s_and_b32 s80, s80, 31
    s_mul_i32 s76, s80, 3072
    s_add_u32 s76, s76, 589824
    buffer_load_dwordx4 v[148:151], v1, s[36:39], s76 offen offset:0 nt
    s_waitcnt vmcnt(6)
    s_cbranch_vccz L_aw8
    s_waitcnt vmcnt(4)
L_aw8:
    buffer_load_dwordx4 v[152:155], v1, s[36:39], s76 offen offset:128 nt
    s_waitcnt vmcnt(6)
    s_cbranch_vccz L_aw9
    s_waitcnt vmcnt(4)
L_aw9:
    buffer_load_dwordx4 v[156:159], v1, s[36:39], s76 offen offset:256 nt
    s_waitcnt vmcnt(6)
    s_cbranch_vccz L_aw10
    s_waitcnt vmcnt(4)
L_aw10:
    s_add_u32 s80, s80, 3
    s_and_b32 s80, s80, 31
    s_mul_i32 s76, s80, 3072
    s_add_u32 s76, s76, 688128
    buffer_load_dwordx4 v[160:163], v1, s[36:39], s76 offen offset:0 nt
    s_waitcnt vmcnt(6)
    s_cbranch_vccz L_aw11
    s_waitcnt vmcnt(4)
L_aw11:
    buffer_load_dwordx4 v[164:167], v1, s[36:39], s76 offen offset:128 nt
    s_waitcnt vmcnt(6)
    s_cbranch_vccz L_aw12
    s_waitcnt vmcnt(4)
L_aw12:
    buffer_load_dwordx4 v[168:171], v1, s[36:39], s76 offen offset:256 nt
    s_waitcnt lgkmcnt(0)
    v_cmp_eq_u32 vcc, 0, v64
    v_add_u32 v65, 1, v65
    ds_write_b32 v57, v65 offset:11056
    ds_read_b32 v64, v58 offset:11015
    s_waitcnt vmcnt(6)
    s_cbranch_vccz L_aw13
    s_waitcnt vmcnt(4)
L_aw13:
    s_add_u32 s80, s80, 3
    s_and_b32 s80, s80, 31
    s_mul_i32 s76, s80, 3072
    s_add_u32 s76, s76, 786432
    buffer_load_dwordx4 v[172:175], v1, s[36:39], s76 offen offset:0 nt
    s_waitcnt vmcnt(6)
    s_cbranch_vccz L_aw14
    s_waitcnt vmcnt(4)
L_aw14:
    buffer_load_dwordx4 v[176:179], v1, s[36:39], s76 offen offset:128 nt
    s_waitcnt vmcnt(6)
    s_cbranch_vccz L_aw15
    s_waitcnt vmcnt(4)
L_aw15:
    buffer_load_dwordx4 v[180:183], v1, s[36:39], s76 offen offset:256 nt
    s_waitcnt vmcnt(6)
    s_cbranch_vccz L_aw16
    s_waitcnt vmcnt(4)
L_aw16:
    s_add_u32 s80, s80, 3
    s_and_b32 s80, s80, 31
    s_mul_i32 s76, s80, 3072
    s_add_u32 s76, s76, 884736
    buffer_load_dwordx4 v[184:187], v1, s[36:39], s76 offen offset:0 nt
    s_waitcnt vmcnt(6)
    s_cbranch_vccz L_aw17
    s_waitcnt vmcnt(4)
L_aw17:
    buffer_load_dwordx4 v[188:191], v1, s[36:39], s76 offen offset:128 nt
    s_waitcnt vmcnt(6)
    s_cbranch_vccz L_aw18
    s_waitcnt vmcnt(4)
L_aw18:
    buffer_load_dwordx4 v[192:195], v1, s[36:39], s76 offen offset:256 nt
    s_waitcnt lgkmcnt(0)
    v_cmp_eq_u32 vcc, 0, v64
    v_add_u32 v65, 1, v65
    ds_write_b32 v57, v65 offset:11056
    ds_read_b32 v64, v58 offset:11015
    s_waitcnt vmcnt(6)
    s_cbranch_vccz L_aw19
    s_waitcnt vmcnt(4)
L_aw19:
    s_add_u32 s80, s80, 3
    s_and_b32 s80, s80, 31
    s_mul_i32 s76, s80, 3072
    s_add_u32 s76, s76, 983040
    buffer_load_dwordx4 v[196:199], v1, s[36:39], s76 offen offset:0 nt
    s_waitcnt vmcnt(6)
    s_cbranch_vccz L_aw20
    s_waitcnt vmcnt(4)
L_aw20:
    buffer_load_dwordx4 v[200:203], v1, s[36:39], s76 offen offset:128 nt
    s_waitcnt vmcnt(6)
    s_cbranch_vccz L_aw21
    s_waitcnt vmcnt(4)
L_aw21:
    buffer_load_dwordx4 v[204:207], v1, s[36:39], s76 offen offset:256 nt
    s_waitcnt vmcnt(6)
    s_cbranch_vccz L_aw22
    s_waitcnt vmcnt(4)
L_aw22:
    s_add_u32 s80, s80, 3
    s_and_b32 s80, s80, 31
    s_mul_i32 s76, s80, 3072
    s_add_u32 s76, s76, 1081344
    buffer_load_dwordx4 v[208:211], v1, s[36:39], s76 offen offset:0 nt
    s_waitcnt vmcnt(6)
    s_cbranch_vccz L_aw23
    s_waitcnt vmcnt(4)
L_aw23:
    buffer_load_dwordx4 v[212:215], v1, s[36:39], s76 offen offset:128 nt
    s_waitcnt vmcnt(6)
    s_cbranch_vccz L_aw24
    s_waitcnt vmcnt(4)
L_aw24:
    buffer_load_dwordx4 v[216:219], v1, s[36:39], s76 offen offset:256 nt
    s_waitcnt lgkmcnt(0)
    v_cmp_eq_u32 vcc, 0, v64
    v_add_u32 v65, 1, v65
    ds_write_b32 v57, v65 offset:11056
    ds_read_b32 v64, v58 offset:11015
    s_waitcnt vmcnt(6)
    s_cbranch_vccz L_aw25
    s_waitcnt vmcnt(4)
L_aw25:
    s_add_u32 s80, s80, 3
    s_and_b32 s80, s80, 31
    s_mul_i32 s76, s80, 3072
    s_add_u32 s76, s76, 1179648
    buffer_load_dwordx4 v[220:223], v1, s[36:39], s76 offen offset:0 nt
    s_waitcnt vmcnt(6)
    s_cbranch_vccz L_aw26
    s_waitcnt vmcnt(4)
L_aw26:
    buffer_load_dwordx4 v[224:227], v1, s[36:39], s76 offen offset:128 nt
    s_waitcnt vmcnt(6)
    s_cbranch_vccz L_aw27
    s_waitcnt vmcnt(4)
L_aw27:
    buffer_load_dwordx4 v[228:231], v1, s[36:39], s76 offen offset:256 nt
    s_waitcnt vmcnt(6)
    s_cbranch_vccz L_aw28
    s_waitcnt vmcnt(4)
L_aw28:
    s_add_u32 s80, s80, 3
    s_and_b32 s80, s80, 31
    s_mul_i32 s76, s80, 3072
    s_add_u32 s76, s76, 1277952
    buffer_load_dwordx4 v[232:235], v1, s[36:39], s76 offen offset:0 nt
    s_waitcnt vmcnt(6)
    s_cbranch_vccz L_aw29
    s_waitcnt vmcnt(4)
L_aw29:
    buffer_load_dwordx4 v[236:239], v1, s[36:39], s76 offen offset:128 nt
    s_waitcnt vmcnt(6)
    s_cbranch_vccz L_aw30
    s_waitcnt vmcnt(4)
L_aw30:
    buffer_load_dwordx4 v[240:243], v1, s[36:39], s76 offen offset:256 nt
    s_waitcnt lgkmcnt(0)
    v_cmp_eq_u32 vcc, 0, v64
    v_add_u32 v65, 1, v65
    ds_write_b32 v57, v65 offset:11056
    ds_read_b32 v64, v58 offset:11015
    s_waitcnt vmcnt(6)
    s_cbranch_vccz L_aw31
    s_waitcnt vmcnt(4)
L_aw31:
    s_add_u32 s80, s80, 3
    s_and_b32 s80, s80, 31
    s_mul_i32 s76, s80, 3072
    s_add_u32 s76, s76, 1376256
    buffer_load_dwordx4 v[244:247], v1, s[36:39], s76 offen offset:0 nt
    s_waitcnt vmcnt(6)
    s_cbranch_vccz L_aw32
    s_waitcnt vmcnt(4)
L_aw32:
    buffer_load_dwordx4 v[248:251], v1, s[36:39], s76 offen offset:128 nt
    s_waitcnt vmcnt(6)
    s_cbranch_vccz L_aw33
    s_waitcnt vmcnt(4)
L_aw33:
    buffer_load_dwordx4 v[252:255], v1, s[36:39], s76 offen offset:256 nt
L_qw:
    s_nop 4
    s_sub_u32 s75, s75, 1
    s_cbranch_scc1 L_end
    ds_read_b32 v4, v58 offset:11019
    s_waitcnt lgkmcnt(0)
    v_readfirstlane_b32 s34, v4
    s_nop 0
    s_cmp_eq_u32 s34, 0
    s_cbranch_scc1 L_qw
    v_lshlrev_b32 v2, 4, v63
    s_mul_i32 s34, s6, 384
    v_add_u32 v2, s34, v2
    ds_read_b128 v[4:7], v2 offset:2048
    ds_read_b128 v[8:11], v2 offset:2176
    ds_read_b128 v[12:15], v2 offset:2304
    s_mov_b32 s8, 0xaaaaaaaa
    s_mov_b32 s9, 0xaaaaaaaa
    s_mov_b32 s10, 0xcccccccc
    s_mov_b32 s11, 0xcccccccc
    v_and_b32 v3, 31, v0
    v_lshl_add_u32 v59, v3, 3, s72
    s_waitcnt lgkmcnt(0)
    v_mov_b32 v16, 0
    v_mov_b32 v28, 0
    v_mov_b32 v29, 0
    v_dot2c_f32_bf16 v16, v76, v4
    v_dot2c_f32_bf16 v28, v80, v8
    v_dot2c_f32_bf16 v29, v84, v12
    v_dot2c_f32_bf16 v16, v77, v5
    v_dot2c_f32_bf16 v28, v81, v9
    v_dot2c_f32_bf16 v29, v85, v13
    v_dot2c_f32_bf16 v16, v78, v6
    v_dot2c_f32_bf16 v28, v82, v10
    v_dot2c_f32_bf16 v29, v86, v14
    v_dot2c_f32_bf16 v16, v79, v7
    v_dot2c_f32_bf16 v28, v83, v11
    v_dot2c_f32_bf16 v29, v87, v15
    s_nop 2
    v_add_f32 v28, v28, v29
    v_add_f32 v16, v16, v28
    s_waitcnt vmcnt(6)
    s_cbranch_vccz L_aw34
    s_waitcnt vmcnt(4)
L_aw34:
    s_add_u32 s80, s80, 3
    s_and_b32 s80, s80, 31
    s_mul_i32 s76, s80, 3072
    s_add_u32 s76, s76, 1474560
    buffer_load_dwordx4 v[76:79], v1, s[36:39], s76 offen offset:0 nt
    v_mov_b32 v17, 0
    v_mov_b32 v28, 0
    v_mov_b32 v29, 0
    v_dot2c_f32_bf16 v17, v88, v4
    v_dot2c_f32_bf16 v28, v92, v8
    v_dot2c_f32_bf16 v29, v96, v12
    v_dot2c_f32_bf16 v17, v89, v5
    v_dot2c_f32_bf16 v28, v93, v9
    v_dot2c_f32_bf16 v29, v97, v13
    v_dot2c_f32_bf16 v17, v90, v6
    v_dot2c_f32_bf16 v28, v94, v10
    v_dot2c_f32_bf16 v29, v98, v14
    v_dot2c_f32_bf16 v17, v91, v7
    v_dot2c_f32_bf16 v28, v95, v11
    v_dot2c_f32_bf16 v29, v99, v15
    s_nop 2
    v_add_f32 v28, v28, v29
    v_add_f32 v17, v17, v28
    s_waitcnt vmcnt(6)
    s_cbranch_vccz L_aw35
    s_waitcnt vmcnt(4)
L_aw35:
    buffer_load_dwordx4 v[80:83], v1, s[36:39], s76 offen offset:128 nt
    v_mov_b32 v18, 0
    v_mov_b32 v28, 0
    v_mov_b32 v29, 0
    v_dot2c_f32_bf16 v18, v100, v4
    v_dot2c_f32_bf16 v28, v104, v8
    v_dot2c_f32_bf16 v29, v108, v12
    v_dot2c_f32_bf16 v18, v101, v5
    v_dot2c_f32_bf16 v28, v105, v9
    v_dot2c_f32_bf16 v29, v109, v13
    v_dot2c_f32_bf16 v18, v102, v6
    v_dot2c_f32_bf16 v28, v106, v10
    v_dot2c_f32_bf16 v29, v110, v14
    v_dot2c_f32_bf16 v18, v103, v7
    v_dot2c_f32_bf16 v28, v107, v11
    v_dot2c_f32_bf16 v29, v111, v15
    s_nop 2
    v_add_f32 v28, v28, v29
    v_add_f32 v18, v18, v28
    s_waitcnt vmcnt(6)
    s_cbranch_vccz L_aw36
    s_waitcnt vmcnt(4)
L_aw36:
    buffer_load_dwordx4 v[84:87], v1, s[36:39], s76 offen offset:256 nt
    v_mov_b32 v19, 0
    v_mov_b32 v28, 0
    v_mov_b32 v29, 0
    v_dot2c_f32_bf16 v19, v112, v4
    v_dot2c_f32_bf16 v28, v116, v8
    v_dot2c_f32_bf16 v29, v120, v12
    v_dot2c_f32_bf16 v19, v113, v5
    v_dot2c_f32_bf16 v28, v117, v9
    v_dot2c_f32_bf16 v29, v121, v13
    v_dot2c_f32_bf16 v19, v114, v6
    v_dot2c_f32_bf16 v28, v118, v10
    v_dot2c_f32_bf16 v29, v122, v14
    v_dot2c_f32_bf16 v19, v115, v7
    v_dot2c_f32_bf16 v28, v119, v11
    v_dot2c_f32_bf16 v29, v123, v15
    s_nop 2
    v_add_f32 v28, v28, v29
    v_add_f32 v19, v19, v28
    s_waitcnt lgkmcnt(0)
    v_cmp_eq_u32 vcc, 0, v64
    v_add_u32 v65, 1, v65
    ds_write_b32 v57, v65 offset:11056
    ds_read_b32 v64, v58 offset:11015
    s_waitcnt vmcnt(6)
    s_cbranch_vccz L_aw37
    s_waitcnt vmcnt(4)
L_aw37:
    s_add_u32 s80, s80, 3
    s_and_b32 s80, s80, 31
    s_mul_i32 s76, s80, 3072
    s_add_u32 s76, s76, 1572864
    buffer_load_dwordx4 v[88:91], v1, s[36:39], s76 offen offset:0 nt
    v_mov_b32 v20, 0
    v_mov_b32 v28, 0
    v_mov_b32 v29, 0
    v_dot2c_f32_bf16 v20, v124, v4
    v_dot2c_f32_bf16 v28, v128, v8
    v_dot2c_f32_bf16 v29, v132, v12
    v_dot2c_f32_bf16 v20, v125, v5
    v_dot2c_f32_bf16 v28, v129, v9
    v_dot2c_f32_bf16 v29, v133, v13
    v_dot2c_f32_bf16 v20, v126, v6
    v_dot2c_f32_bf16 v28, v130, v10
    v_dot2c_f32_bf16 v29, v134, v14
    v_dot2c_f32_bf16 v20, v127, v7
    v_dot2c_f32_bf16 v28, v131, v11
    v_dot2c_f32_bf16 v29, v135, v15
    s_nop 2
    v_add_f32 v28, v28, v29
    v_add_f32 v20, v20, v28
    s_waitcnt vmcnt(6)
    s_cbranch_vccz L_aw38
    s_waitcnt vmcnt(4)
L_aw38:
    buffer_load_dwordx4 v[92:95], v1, s[36:39], s76 offen offset:128 nt
    v_mov_b32 v21, 0
    v_mov_b32 v28, 0
    v_mov_b32 v29, 0
    v_dot2c_f32_bf16 v21, v136, v4
    v_dot2c_f32_bf16 v28, v140, v8
    v_dot2c_f32_bf16 v29, v144, v12
    v_dot2c_f32_bf16 v21, v137, v5
    v_dot2c_f32_bf16 v28, v141, v9
    v_dot2c_f32_bf16 v29, v145, v13
    v_dot2c_f32_bf16 v21, v138, v6
    v_dot2c_f32_bf16 v28, v142, v10
    v_dot2c_f32_bf16 v29, v146, v14
    v_dot2c_f32_bf16 v21, v139, v7
    v_dot2c_f32_bf16 v28, v143, v11
    v_dot2c_f32_bf16 v29, v147, v15
    s_nop 2
    v_add_f32 v28, v28, v29
    v_add_f32 v21, v21, v28
    s_waitcnt vmcnt(6)
    s_cbranch_vccz L_aw39
    s_waitcnt vmcnt(4)
L_aw39:
    buffer_load_dwordx4 v[96:99], v1, s[36:39], s76 offen offset:256 nt
    v_mov_b32 v22, 0
    v_mov_b32 v28, 0
    v_mov_b32 v29, 0
    v_dot2c_f32_bf16 v22, v148, v4
    v_dot2c_f32_bf16 v28, v152, v8
    v_dot2c_f32_bf16 v29, v156, v12
    v_dot2c_f32_bf16 v22, v149, v5
    v_dot2c_f32_bf16 v28, v153, v9
    v_dot2c_f32_bf16 v29, v157, v13
    v_dot2c_f32_bf16 v22, v150, v6
    v_dot2c_f32_bf16 v28, v154, v10
    v_dot2c_f32_bf16 v29, v158, v14
    v_dot2c_f32_bf16 v22, v151, v7
    v_dot2c_f32_bf16 v28, v155, v11
    v_dot2c_f32_bf16 v29, v159, v15
    s_nop 2
    v_add_f32 v28, v28, v29
    v_add_f32 v22, v22, v28
    s_waitcnt vmcnt(6)
    s_cbranch_vccz L_aw40
    s_waitcnt vmcnt(4)
L_aw40:
    s_add_u32 s80, s80, 3
    s_and_b32 s80, s80, 31
    s_mul_i32 s76, s80, 3072
    s_add_u32 s76, s76, 1671168
    buffer_load_dwordx4 v[100:103], v1, s[36:39], s76 offen offset:0 nt
    v_mov_b32 v23, 0
    v_mov_b32 v28, 0
    v_mov_b32 v29, 0
    v_dot2c_f32_bf16 v23, v160, v4
    v_dot2c_f32_bf16 v28, v164, v8
    v_dot2c_f32_bf16 v29, v168, v12
    v_dot2c_f32_bf16 v23, v161, v5
    v_dot2c_f32_bf16 v28, v165, v9
    v_dot2c_f32_bf16 v29, v169, v13
    v_dot2c_f32_bf16 v23, v162, v6
    v_dot2c_f32_bf16 v28, v166, v10
    v_dot2c_f32_bf16 v29, v170, v14
    v_dot2c_f32_bf16 v23, v163, v7
    v_dot2c_f32_bf16 v28, v167, v11
    v_dot2c_f32_bf16 v29, v171, v15
    s_nop 2
    v_add_f32 v28, v28, v29
    v_add_f32 v23, v23, v28
    v_add_f32_dpp v16, v16, v16 row_shl:4 row_mask:0xf bank_mask:0x5
    v_add_f32_dpp v17, v17, v17 row_shl:4 row_mask:0xf bank_mask:0x5
    v_add_f32_dpp v18, v18, v18 row_shl:4 row_mask:0xf bank_mask:0x5
    v_add_f32_dpp v19, v19, v19 row_shl:4 row_mask:0xf bank_mask:0x5
    v_add_f32_dpp v16, v20, v20 row_shr:4 row_mask:0xf bank_mask:0xa
    v_add_f32_dpp v17, v21, v21 row_shr:4 row_mask:0xf bank_mask:0xa
    v_add_f32_dpp v18, v22, v22 row_shr:4 row_mask:0xf bank_mask:0xa
    v_add_f32_dpp v19, v23, v23 row_shr:4 row_mask:0xf bank_mask:0xa
    v_add_f32_dpp v16, v16, v16 quad_perm:[2,3,0,1] row_mask:0xf bank_mask:0xf
    v_add_f32_dpp v17, v17, v17 quad_perm:[2,3,0,1] row_mask:0xf bank_mask:0xf
    v_add_f32_dpp v18, v18, v18 quad_perm:[2,3,0,1] row_mask:0xf bank_mask:0xf
    v_add_f32_dpp v19, v19, v19 quad_perm:[2,3,0,1] row_mask:0xf bank_mask:0xf
    v_cndmask_b32 v16, v16, v18, s[10:11]
    v_cndmask_b32 v17, v17, v19, s[10:11]
    s_nop 0
    v_add_f32_dpp v16, v16, v16 quad_perm:[1,0,3,2] row_mask:0xf bank_mask:0xf
    v_add_f32_dpp v17, v17, v17 quad_perm:[1,0,3,2] row_mask:0xf bank_mask:0xf
    v_cndmask_b32 v24, v16, v17, s[8:9]
    s_waitcnt vmcnt(6)
    s_cbranch_vccz L_aw41
    s_waitcnt vmcnt(4)
L_aw41:
    buffer_load_dwordx4 v[104:107], v1, s[36:39], s76 offen offset:128 nt
    v_mov_b32 v16, 0
    v_mov_b32 v28, 0
    v_mov_b32 v29, 0
    v_dot2c_f32_bf16 v16, v172, v4
    v_dot2c_f32_bf16 v28, v176, v8
    v_dot2c_f32_bf16 v29, v180, v12
    v_dot2c_f32_bf16 v16, v173, v5
    v_dot2c_f32_bf16 v28, v177, v9
    v_dot2c_f32_bf16 v29, v181, v13
    v_dot2c_f32_bf16 v16, v174, v6
    v_dot2c_f32_bf16 v28, v178, v10
    v_dot2c_f32_bf16 v29, v182, v14
    v_dot2c_f32_bf16 v16, v175, v7
    v_dot2c_f32_bf16 v28, v179, v11
    v_dot2c_f32_bf16 v29, v183, v15
    s_nop 2
    v_add_f32 v28, v28, v29
    v_add_f32 v16, v16, v28
    s_waitcnt vmcnt(6)
    s_cbranch_vccz L_aw42
    s_waitcnt vmcnt(4)
L_aw42:
    buffer_load_dwordx4 v[108:111], v1, s[36:39], s76 offen offset:256 nt
    v_mov_b32 v17, 0
    v_mov_b32 v28, 0
    v_mov_b32 v29, 0
    v_dot2c_f32_bf16 v17, v184, v4
    v_dot2c_f32_bf16 v28, v188, v8
    v_dot2c_f32_bf16 v29, v192, v12
    v_dot2c_f32_bf16 v17, v185, v5
    v_dot2c_f32_bf16 v28, v189, v9
    v_dot2c_f32_bf16 v29, v193, v13
    v_dot2c_f32_bf16 v17, v186, v6
    v_dot2c_f32_bf16 v28, v190, v10
    v_dot2c_f32_bf16 v29, v194, v14
    v_dot2c_f32_bf16 v17, v187, v7
    v_dot2c_f32_bf16 v28, v191, v11
    v_dot2c_f32_bf16 v29, v195, v15
    s_nop 2
    v_add_f32 v28, v28, v29
    v_add_f32 v17, v17, v28
    s_waitcnt lgkmcnt(0)
    v_cmp_eq_u32 vcc, 0, v64
    v_add_u32 v65, 1, v65
    ds_write_b32 v57, v65 offset:11056
    ds_read_b32 v64, v58 offset:11015
    s_waitcnt vmcnt(6)
    s_cbranch_vccz L_aw43
    s_waitcnt vmcnt(4)
L_aw43:
    s_add_u32 s80, s80, 3
    s_and_b32 s80, s80, 31
    s_mul_i32 s76, s80, 3072
    s_add_u32 s76, s76, 1769472
    buffer_load_dwordx4 v[112:115], v1, s[36:39], s76 offen offset:0 nt
    v_mov_b32 v18, 0
    v_mov_b32 v28, 0
    v_mov_b32 v29, 0
    v_dot2c_f32_bf16 v18, v196, v4
    v_dot2c_f32_bf16 v28, v200, v8
    v_dot2c_f32_bf16 v29, v204, v12
    v_dot2c_f32_bf16 v18, v197, v5
    v_dot2c_f32_bf16 v28, v201, v9
    v_dot2c_f32_bf16 v29, v205, v13
    v_dot2c_f32_bf16 v18, v198, v6
    v_dot2c_f32_bf16 v28, v202, v10
    v_dot2c_f32_bf16 v29, v206, v14
    v_dot2c_f32_bf16 v18, v199, v7
    v_dot2c_f32_bf16 v28, v203, v11
    v_dot2c_f32_bf16 v29, v207, v15
    s_nop 2
    v_add_f32 v28, v28, v29
    v_add_f32 v18, v18, v28
    s_waitcnt vmcnt(6)
    s_cbranch_vccz L_aw44
    s_waitcnt vmcnt(4)
L_aw44:
    buffer_load_dwordx4 v[116:119], v1, s[36:39], s76 offen offset:128 nt
    v_mov_b32 v19, 0
    v_mov_b32 v28, 0
    v_mov_b32 v29, 0
    v_dot2c_f32_bf16 v19, v208, v4
    v_dot2c_f32_bf16 v28, v212, v8
    v_dot2c_f32_bf16 v29, v216, v12
    v_dot2c_f32_bf16 v19, v209, v5
    v_dot2c_f32_bf16 v28, v213, v9
    v_dot2c_f32_bf16 v29, v217, v13
    v_dot2c_f32_bf16 v19, v210, v6
    v_dot2c_f32_bf16 v28, v214, v10
    v_dot2c_f32_bf16 v29, v218, v14
    v_dot2c_f32_bf16 v19, v211, v7
    v_dot2c_f32_bf16 v28, v215, v11
    v_dot2c_f32_bf16 v29, v219, v15
    s_nop 2
    v_add_f32 v28, v28, v29
    v_add_f32 v19, v19, v28
    s_waitcnt vmcnt(6)
    s_cbranch_vccz L_aw45
    s_waitcnt vmcnt(4)
L_aw45:
    buffer_load_dwordx4 v[120:123], v1, s[36:39], s76 offen offset:256 nt
    v_mov_b32 v20, 0
    v_mov_b32 v28, 0
    v_mov_b32 v29, 0
    v_dot2c_f32_bf16 v20, v220, v4
    v_dot2c_f32_bf16 v28, v224, v8
    v_dot2c_f32_bf16 v29, v228, v12
    v_dot2c_f32_bf16 v20, v221, v5
    v_dot2c_f32_bf16 v28, v225, v9
    v_dot2c_f32_bf16 v29, v229, v13
    v_dot2c_f32_bf16 v20, v222, v6
    v_dot2c_f32_bf16 v28, v226, v10
    v_dot2c_f32_bf16 v29, v230, v14
    v_dot2c_f32_bf16 v20, v223, v7
    v_dot2c_f32_bf16 v28, v227, v11
    v_dot2c_f32_bf16 v29, v231, v15
    s_nop 2
    v_add_f32 v28, v28, v29
    v_add_f32 v20, v20, v28
    s_waitcnt vmcnt(6)
    s_cbranch_vccz L_aw46
    s_waitcnt vmcnt(4)
L_aw46:
    s_add_u32 s80, s80, 3
    s_and_b32 s80, s80, 31
    s_mul_i32 s76, s80, 3072
    s_add_u32 s76, s76, 1867776
    buffer_load_dwordx4 v[124:127], v1, s[36:39], s76 offen offset:0 nt
    v_mov_b32 v21, 0
    v_mov_b32 v28, 0
    v_mov_b32 v29, 0
    v_dot2c_f32_bf16 v21, v232, v4
    v_dot2c_f32_bf16 v28, v236, v8
    v_dot2c_f32_bf16 v29, v240, v12
    v_dot2c_f32_bf16 v21, v233, v5
    v_dot2c_f32_bf16 v28, v237, v9
    v_dot2c_f32_bf16 v29, v241, v13
    v_dot2c_f32_bf16 v21, v234, v6
    v_dot2c_f32_bf16 v28, v238, v10
    v_dot2c_f32_bf16 v29, v242, v14
    v_dot2c_f32_bf16 v21, v235, v7
    v_dot2c_f32_bf16 v28, v239, v11
    v_dot2c_f32_bf16 v29, v243, v15
    s_nop 2
    v_add_f32 v28, v28, v29
    v_add_f32 v21, v21, v28
    s_waitcnt vmcnt(6)
    s_cbranch_vccz L_aw47
    s_waitcnt vmcnt(4)
L_aw47:
    buffer_load_dwordx4 v[128:131], v1, s[36:39], s76 offen offset:128 nt
    v_mov_b32 v22, 0
    v_mov_b32 v28, 0
    v_mov_b32 v29, 0
    v_dot2c_f32_bf16 v22, v244, v4
    v_dot2c_f32_bf16 v28, v248, v8
    v_dot2c_f32_bf16 v29, v252, v12
    v_dot2c_f32_bf16 v22, v245, v5
    v_dot2c_f32_bf16 v28, v249, v9
    v_dot2c_f32_bf16 v29, v253, v13
    v_dot2c_f32_bf16 v22, v246, v6
    v_dot2c_f32_bf16 v28, v250, v10
    v_dot2c_f32_bf16 v29, v254, v14
    v_dot2c_f32_bf16 v22, v247, v7
    v_dot2c_f32_bf16 v28, v251, v11
    v_dot2c_f32_bf16 v29, v255, v15
    s_nop 2
    v_add_f32 v28, v28, v29
    v_add_f32 v22, v22, v28
    s_waitcnt vmcnt(6)
    s_cbranch_vccz L_aw48
    s_waitcnt vmcnt(4)
L_aw48:
    buffer_load_dwordx4 v[132:135], v1, s[36:39], s76 offen offset:256 nt
    v_mov_b32 v23, 0
    v_mov_b32 v28, 0
    v_mov_b32 v29, 0
    v_dot2c_f32_bf16 v23, v76, v4
    v_dot2c_f32_bf16 v28, v80, v8
    v_dot2c_f32_bf16 v29, v84, v12
    v_dot2c_f32_bf16 v23, v77, v5
    v_dot2c_f32_bf16 v28, v81, v9
    v_dot2c_f32_bf16 v29, v85, v13
    v_dot2c_f32_bf16 v23, v78, v6
    v_dot2c_f32_bf16 v28, v82, v10
    v_dot2c_f32_bf16 v29, v86, v14
    v_dot2c_f32_bf16 v23, v79, v7
    v_dot2c_f32_bf16 v28, v83, v11
    v_dot2c_f32_bf16 v29, v87, v15
    s_nop 2
    v_add_f32 v28, v28, v29
    v_add_f32 v23, v23, v28
    v_add_f32_dpp v16, v16, v16 row_shl:4 row_mask:0xf bank_mask:0x5
    v_add_f32_dpp v17, v17, v17 row_shl:4 row_mask:0xf bank_mask:0x5
    v_add_f32_dpp v18, v18, v18 row_shl:4 row_mask:0xf bank_mask:0x5
    v_add_f32_dpp v19, v19, v19 row_shl:4 row_mask:0xf bank_mask:0x5
    v_add_f32_dpp v16, v20, v20 row_shr:4 row_mask:0xf bank_mask:0xa
    v_add_f32_dpp v17, v21, v21 row_shr:4 row_mask:0xf bank_mask:0xa
    v_add_f32_dpp v18, v22, v22 row_shr:4 row_mask:0xf bank_mask:0xa
    v_add_f32_dpp v19, v23, v23 row_shr:4 row_mask:0xf bank_mask:0xa
    v_add_f32_dpp v16, v16, v16 quad_perm:[2,3,0,1] row_mask:0xf bank_mask:0xf
    v_add_f32_dpp v17, v17, v17 quad_perm:[2,3,0,1] row_mask:0xf bank_mask:0xf
    v_add_f32_dpp v18, v18, v18 quad_perm:[2,3,0,1] row_mask:0xf bank_mask:0xf
    v_add_f32_dpp v19, v19, v19 quad_perm:[2,3,0,1] row_mask:0xf bank_mask:0xf
    v_cndmask_b32 v16, v16, v18, s[10:11]
    v_cndmask_b32 v17, v17, v19, s[10:11]
    s_nop 0
    v_add_f32_dpp v16, v16, v16 quad_perm:[1,0,3,2] row_mask:0xf bank_mask:0xf
    v_add_f32_dpp v17, v17, v17 quad_perm:[1,0,3,2] row_mask:0xf bank_mask:0xf
    v_cndmask_b32 v25, v16, v17, s[8:9]
    s_waitcnt lgkmcnt(0)
    v_cmp_eq_u32 vcc, 0, v64
    v_add_u32 v65, 1, v65
    ds_write_b32 v57, v65 offset:11056
    ds_read_b32 v64, v58 offset:11015
    s_waitcnt vmcnt(6)
    s_cbranch_vccz L_aw49
    s_waitcnt vmcnt(4)
L_aw49:
    s_add_u32 s80, s80, 3
    s_and_b32 s80, s80, 31
    s_mul_i32 s76, s80, 3072
    s_add_u32 s76, s76, 1966080
    buffer_load_dwordx4 v[136:139], v1, s[36:39], s76 offen offset:0 nt
    v_mov_b32 v16, 0
    v_mov_b32 v28, 0
    v_mov_b32 v29, 0
    v_dot2c_f32_bf16 v16, v88, v4
    v_dot2c_f32_bf16 v28, v92, v8
    v_dot2c_f32_bf16 v29, v96, v12
    v_dot2c_f32_bf16 v16, v89, v5
    v_dot2c_f32_bf16 v28, v93, v9
    v_dot2c_f32_bf16 v29, v97, v13
    v_dot2c_f32_bf16 v16, v90, v6
    v_dot2c_f32_bf16 v28, v94, v10
    v_dot2c_f32_bf16 v29, v98, v14
    v_dot2c_f32_bf16 v16, v91, v7
    v_dot2c_f32_bf16 v28, v95, v11
    v_dot2c_f32_bf16 v29, v99, v15
    s_nop 2
    v_add_f32 v28, v28, v29
    v_add_f32 v16, v16, v28
    s_waitcnt vmcnt(6)
    s_cbranch_vccz L_aw50
    s_waitcnt vmcnt(4)
L_aw50:
    buffer_load_dwordx4 v[140:143], v1, s[36:39], s76 offen offset:128 nt
    v_mov_b32 v17, 0
    v_mov_b32 v28, 0
    v_mov_b32 v29, 0
    v_dot2c_f32_bf16 v17, v100, v4
    v_dot2c_f32_bf16 v28, v104, v8
    v_dot2c_f32_bf16 v29, v108, v12
    v_dot2c_f32_bf16 v17, v101, v5
    v_dot2c_f32_bf16 v28, v105, v9
    v_dot2c_f32_bf16 v29, v109, v13
    v_dot2c_f32_bf16 v17, v102, v6
    v_dot2c_f32_bf16 v28, v106, v10
    v_dot2c_f32_bf16 v29, v110, v14
    v_dot2c_f32_bf16 v17, v103, v7
    v_dot2c_f32_bf16 v28, v107, v11
    v_dot2c_f32_bf16 v29, v111, v15
    s_nop 2
    v_add_f32 v28, v28, v29
    v_add_f32 v17, v17, v28
    s_waitcnt vmcnt(6)
    s_cbranch_vccz L_aw51
    s_waitcnt vmcnt(4)
L_aw51:
    buffer_load_dwordx4 v[144:147], v1, s[36:39], s76 offen offset:256 nt
    v_mov_b32 v18, 0
    v_mov_b32 v28, 0
    v_dot2c_f32_bf16 v18, v112, v4
    v_dot2c_f32_bf16 v28, v113, v5
    v_dot2c_f32_bf16 v18, v114, v6
    v_dot2c_f32_bf16 v28, v115, v7
    v_dot2c_f32_bf16 v18, v116, v8
    v_dot2c_f32_bf16 v28, v117, v9
    v_dot2c_f32_bf16 v18, v118, v10
    v_dot2c_f32_bf16 v28, v119, v11
    s_waitcnt vmcnt(6)
    s_cbranch_vccz L_aw52
    s_waitcnt vmcnt(4)
L_aw52:
    s_add_u32 s80, s80, 3
    s_and_b32 s80, s80, 31
    s_mul_i32 s76, s80, 3072
    s_add_u32 s76, s76, 2064384
    buffer_load_dwordx4 v[148:151], v1, s[36:39], s76 offen offset:0 nt
    v_dot2c_f32_bf16 v18, v120, v12
    v_dot2c_f32_bf16 v28, v121, v13
    v_dot2c_f32_bf16 v18, v122, v14
    v_dot2c_f32_bf16 v28, v123, v15
    s_nop 2
    v_add_f32 v18, v18, v28
    s_waitcnt vmcnt(6)
    s_cbranch_vccz L_aw53
    s_waitcnt vmcnt(4)
L_aw53:
    buffer_load_dwordx4 v[152:155], v1, s[36:39], s76 offen offset:128 nt
    v_mov_b32 v19, 0
    v_mov_b32 v28, 0
    v_dot2c_f32_bf16 v19, v124, v4
    v_dot2c_f32_bf16 v28, v125, v5
    v_dot2c_f32_bf16 v19, v126, v6
    v_dot2c_f32_bf16 v28, v127, v7
    s_waitcnt vmcnt(6)
    s_cbranch_vccz L_aw54
    s_waitcnt vmcnt(4)
L_aw54:
    buffer_load_dwordx4 v[156:159], v1, s[36:39], s76 offen offset:256 nt
    v_dot2c_f32_bf16 v19, v128, v8
    v_dot2c_f32_bf16 v28, v129, v9
    v_dot2c_f32_bf16 v19, v130, v10
    v_dot2c_f32_bf16 v28, v131, v11
    s_waitcnt lgkmcnt(0)
    v_cmp_eq_u32 vcc, 0, v64
    v_add_u32 v65, 1, v65
    ds_write_b32 v57, v65 offset:11056
    ds_read_b32 v64, v58 offset:11015
    s_waitcnt vmcnt(6)
    s_cbranch_vccz L_aw55
    s_waitcnt vmcnt(4)
L_aw55:
    s_add_u32 s80, s80, 3
    s_and_b32 s80, s80, 31
    s_mul_i32 s76, s80, 3072
    s_add_u32 s76, s76, 2162688
    buffer_load_dwordx4 v[160:163], v1, s[36:39], s76 offen offset:0 nt
    v_dot2c_f32_bf16 v19, v132, v12
    v_dot2c_f32_bf16 v28, v133, v13
    v_dot2c_f32_bf16 v19, v134, v14
    v_dot2c_f32_bf16 v28, v135, v15
    s_nop 2
    v_add_f32 v19, v19, v28
    s_waitcnt vmcnt(6)
    s_cbranch_vccz L_aw56
    s_waitcnt vmcnt(4)
L_aw56:
    buffer_load_dwordx4 v[164:167], v1, s[36:39], s76 offen offset:128 nt
    v_mov_b32 v20, 0
    v_mov_b32 v28, 0
    v_dot2c_f32_bf16 v20, v136, v4
    v_dot2c_f32_bf16 v28, v137, v5
    v_dot2c_f32_bf16 v20, v138, v6
    v_dot2c_f32_bf16 v28, v139, v7
    s_waitcnt vmcnt(6)
    s_cbranch_vccz L_aw57
    s_waitcnt vmcnt(4)
L_aw57:
    buffer_load_dwordx4 v[168:171], v1, s[36:39], s76 offen offset:256 nt
    v_dot2c_f32_bf16 v20, v140, v8
    v_dot2c_f32_bf16 v28, v141, v9
    v_dot2c_f32_bf16 v20, v142, v10
    v_dot2c_f32_bf16 v28, v143, v11
    s_waitcnt vmcnt(6)
    s_cbranch_vccz L_aw58
    s_waitcnt vmcnt(4)
L_aw58:
    s_add_u32 s80, s80, 3
    s_and_b32 s80, s80, 31
    s_mul_i32 s76, s80, 3072
    s_add_u32 s76, s76, 2260992
    buffer_load_dwordx4 v[172:175], v1, s[36:39], s76 offen offset:0 nt
    v_dot2c_f32_bf16 v20, v144, v12
    v_dot2c_f32_bf16 v28, v145, v13
    v_dot2c_f32_bf16 v20, v146, v14
    v_dot2c_f32_bf16 v28, v147, v15
    s_nop 2
    v_add_f32 v20, v20, v28
    s_waitcnt vmcnt(6)
    s_cbranch_vccz L_aw59
    s_waitcnt vmcnt(4)
L_aw59:
    buffer_load_dwordx4 v[176:179], v1, s[36:39], s76 offen offset:128 nt
    v_mov_b32 v21, 0
    v_mov_b32 v28, 0
    v_dot2c_f32_bf16 v21, v148, v4
    v_dot2c_f32_bf16 v28, v149, v5
    v_dot2c_f32_bf16 v21, v150, v6
    v_dot2c_f32_bf16 v28, v151, v7
    s_waitcnt vmcnt(6)
    s_cbranch_vccz L_aw60
    s_waitcnt vmcnt(4)
L_aw60:
    buffer_load_dwordx4 v[180:183], v1, s[36:39], s76 offen offset:256 nt
    v_dot2c_f32_bf16 v21, v152, v8
    v_dot2c_f32_bf16 v28, v153, v9
    v_dot2c_f32_bf16 v21, v154, v10
    v_dot2c_f32_bf16 v28, v155, v11
    s_waitcnt lgkmcnt(0)
    v_cmp_eq_u32 vcc, 0, v64
    v_add_u32 v65, 1, v65
    ds_write_b32 v57, v65 offset:11056
    ds_read_b32 v64, v58 offset:11015
    s_waitcnt vmcnt(6)
    s_cbranch_vccz L_aw61
    s_waitcnt vmcnt(4)
L_aw61:
    s_add_u32 s80, s80, 3
    s_and_b32 s80, s80, 31
    s_mul_i32 s76, s80, 3072
    s_add_u32 s76, s76, 2359296
    buffer_load_dwordx4 v[184:187], v1, s[36:39], s76 offen offset:0 nt
    v_dot2c_f32_bf16 v21, v156, v12
    v_dot2c_f32_bf16 v28, v157, v13
    v_dot2c_f32_bf16 v21, v158, v14
    v_dot2c_f32_bf16 v28, v159, v15
    s_nop 2
    v_add_f32 v21, v21, v28
    s_waitcnt vmcnt(6)
    s_cbranch_vccz L_aw62
    s_waitcnt vmcnt(4)
L_aw62:
    buffer_load_dwordx4 v[188:191], v1, s[36:39], s76 offen offset:128 nt
    v_mov_b32 v22, 0
    v_mov_b32 v28, 0
    v_dot2c_f32_bf16 v22, v160, v4
    v_dot2c_f32_bf16 v28, v161, v5
    v_dot2c_f32_bf16 v22, v162, v6
    v_dot2c_f32_bf16 v28, v163, v7
    s_waitcnt vmcnt(6)
    s_cbranch_vccz L_aw63
    s_waitcnt vmcnt(4)
L_aw63:
    buffer_load_dwordx4 v[192:195], v1, s[36:39], s76 offen offset:256 nt
    v_dot2c_f32_bf16 v22, v164, v8
    v_dot2c_f32_bf16 v28, v165, v9
    v_dot2c_f32_bf16 v22, v166, v10
    v_dot2c_f32_bf16 v28, v167, v11
    s_waitcnt vmcnt(6)
    s_cbranch_vccz L_aw64
    s_waitcnt vmcnt(4)
L_aw64:
    s_add_u32 s80, s80, 3
    s_and_b32 s80, s80, 31
    s_mul_i32 s76, s80, 3072
    s_add_u32 s76, s76, 2457600
    buffer_load_dwordx4 v[196:199], v1, s[36:39], s76 offen offset:0 nt
    v_dot2c_f32_bf16 v22, v168, v12
    v_dot2c_f32_bf16 v28, v169, v13
    v_dot2c_f32_bf16 v22, v170, v14
    v_dot2c_f32_bf16 v28, v171, v15
    s_nop 2
    v_add_f32 v22, v22, v28
    s_waitcnt vmcnt(6)
    s_cbranch_vccz L_aw65
    s_waitcnt vmcnt(4)
L_aw65:
    buffer_load_dwordx4 v[200:203], v1, s[36:39], s76 offen offset:128 nt
    v_mov_b32 v23, 0
    v_mov_b32 v28, 0
    v_dot2c_f32_bf16 v23, v172, v4
    v_dot2c_f32_bf16 v28, v173, v5
    v_dot2c_f32_bf16 v23, v174, v6
    v_dot2c_f32_bf16 v28, v175, v7
    s_waitcnt vmcnt(6)
    s_cbranch_vccz L_aw66
    s_waitcnt vmcnt(4)
L_aw66:
    buffer_load_dwordx4 v[204:207], v1, s[36:39], s76 offen offset:256 nt
    v_dot2c_f32_bf16 v23, v176, v8
    v_dot2c_f32_bf16 v28, v177, v9
    v_dot2c_f32_bf16 v23, v178, v10
    v_dot2c_f32_bf16 v28, v179, v11
    s_waitcnt lgkmcnt(0)
    v_cmp_eq_u32 vcc, 0, v64
    v_add_u32 v65, 1, v65
    ds_write_b32 v57, v65 offset:11056
    ds_read_b32 v64, v58 offset:11015
    s_waitcnt vmcnt(6)
    s_cbranch_vccz L_aw67
    s_waitcnt vmcnt(4)
L_aw67:
    s_add_u32 s80, s80, 3
    s_and_b32 s80, s80, 31
    s_mul_i32 s76, s80, 3072
    s_add_u32 s76, s76, 2555904
    buffer_load_dwordx4 v[208:211], v1, s[36:39], s76 offen offset:0 nt
    v_dot2c_f32_bf16 v23, v180, v12
    v_dot2c_f32_bf16 v28, v181, v13
    v_dot2c_f32_bf16 v23, v182, v14
    v_dot2c_f32_bf16 v28, v183, v15
    s_nop 2
    v_add_f32 v23, v23, v28
    v_add_f32_dpp v16, v16, v16 row_shl:4 row_mask:0xf bank_mask:0x5
    v_add_f32_dpp v17, v17, v17 row_shl:4 row_mask:0xf bank_mask:0x5
    v_add_f32_dpp v18, v18, v18 row_shl:4 row_mask:0xf bank_mask:0x5
    v_add_f32_dpp v19, v19, v19 row_shl:4 row_mask:0xf bank_mask:0x5
    v_add_f32_dpp v16, v20, v20 row_shr:4 row_mask:0xf bank_mask:0xa
    v_add_f32_dpp v17, v21, v21 row_shr:4 row_mask:0xf bank_mask:0xa
    v_add_f32_dpp v18, v22, v22 row_shr:4 row_mask:0xf bank_mask:0xa
    v_add_f32_dpp v19, v23, v23 row_shr:4 row_mask:0xf bank_mask:0xa
    v_add_f32_dpp v16, v16, v16 quad_perm:[2,3,0,1] row_mask:0xf bank_mask:0xf
    v_add_f32_dpp v17, v17, v17 quad_perm:[2,3,0,1] row_mask:0xf bank_mask:0xf
    v_add_f32_dpp v18, v18, v18 quad_perm:[2,3,0,1] row_mask:0xf bank_mask:0xf
    v_add_f32_dpp v19, v19, v19 quad_perm:[2,3,0,1] row_mask:0xf bank_mask:0xf
    v_cndmask_b32 v16, v16, v18, s[10:11]
    v_cndmask_b32 v17, v17, v19, s[10:11]
    s_nop 0
    v_add_f32_dpp v16, v16, v16 quad_perm:[1,0,3,2] row_mask:0xf bank_mask:0xf
    v_add_f32_dpp v17, v17, v17 quad_perm:[1,0,3,2] row_mask:0xf bank_mask:0xf
    v_cndmask_b32 v26, v16, v17, s[8:9]
    s_waitcnt vmcnt(6)
    s_cbranch_vccz L_aw68
    s_waitcnt vmcnt(4)
L_aw68:
    buffer_load_dwordx4 v[212:215], v1, s[36:39], s76 offen offset:128 nt
    v_mov_b32 v16, 0
    v_mov_b32 v28, 0
    v_dot2c_f32_bf16 v16, v184, v4
    v_dot2c_f32_bf16 v28, v185, v5
    v_dot2c_f32_bf16 v16, v186, v6
    v_dot2c_f32_bf16 v28, v187, v7
    s_waitcnt vmcnt(6)
    s_cbranch_vccz L_aw69
    s_waitcnt vmcnt(4)
L_aw69:
    buffer_load_dwordx4 v[216:219], v1, s[36:39], s76 offen offset:256 nt
    v_dot2c_f32_bf16 v16, v188, v8
    v_dot2c_f32_bf16 v28, v189, v9
    v_dot2c_f32_bf16 v16, v190, v10
    v_dot2c_f32_bf16 v28, v191, v11
    s_waitcnt vmcnt(6)
    s_cbranch_vccz L_aw70
    s_waitcnt vmcnt(4)
L_aw70:
    s_add_u32 s80, s80, 3
    s_and_b32 s80, s80, 31
    s_mul_i32 s76, s80, 3072
    s_add_u32 s76, s76, 2654208
    buffer_load_dwordx4 v[220:223], v1, s[36:39], s76 offen offset:0 nt
    v_dot2c_f32_bf16 v16, v192, v12
    v_dot2c_f32_bf16 v28, v193, v13
    v_dot2c_f32_bf16 v16, v194, v14
    v_dot2c_f32_bf16 v28, v195, v15
    s_nop 2
    v_add_f32 v16, v16, v28
    s_waitcnt vmcnt(6)
    s_cbranch_vccz L_aw71
    s_waitcnt vmcnt(4)
L_aw71:
    buffer_load_dwordx4 v[224:227], v1, s[36:39], s76 offen offset:128 nt
    v_mov_b32 v17, 0
    v_mov_b32 v28, 0
    v_dot2c_f32_bf16 v17, v196, v4
    v_dot2c_f32_bf16 v28, v197, v5
    v_dot2c_f32_bf16 v17, v198, v6
    v_dot2c_f32_bf16 v28, v199, v7
    s_waitcnt vmcnt(6)
    s_cbranch_vccz L_aw72
    s_waitcnt vmcnt(4)
L_aw72:
    buffer_load_dwordx4 v[228:231], v1, s[36:39], s76 offen offset:256 nt
    v_dot2c_f32_bf16 v17, v200, v8
    v_dot2c_f32_bf16 v28, v201, v9
    v_dot2c_f32_bf16 v17, v202, v10
    v_dot2c_f32_bf16 v28, v203, v11
    s_waitcnt lgkmcnt(0)
    v_cmp_eq_u32 vcc, 0, v64
    v_add_u32 v65, 1, v65
    ds_write_b32 v57, v65 offset:11056
    ds_read_b32 v64, v58 offset:11015
    s_waitcnt vmcnt(6)
    s_cbranch_vccz L_aw73
    s_waitcnt vmcnt(4)
L_aw73:
    s_add_u32 s80, s80, 3
    s_and_b32 s80, s80, 31
    s_mul_i32 s76, s80, 3072
    s_add_u32 s76, s76, 2752512
    buffer_load_dwordx4 v[232:235], v1, s[36:39], s76 offen offset:0 nt
    v_dot2c_f32_bf16 v17, v204, v12
    v_dot2c_f32_bf16 v28, v205, v13
    v_dot2c_f32_bf16 v17, v206, v14
    v_dot2c_f32_bf16 v28, v207, v15
    s_nop 2
    v_add_f32 v17, v17, v28
    s_waitcnt vmcnt(6)
    s_cbranch_vccz L_aw74
    s_waitcnt vmcnt(4)
L_aw74:
    buffer_load_dwordx4 v[236:239], v1, s[36:39], s76 offen offset:128 nt
    v_mov_b32 v18, 0
    v_mov_b32 v28, 0
    v_dot2c_f32_bf16 v18, v208, v4
    v_dot2c_f32_bf16 v28, v209, v5
    v_dot2c_f32_bf16 v18, v210, v6
    v_dot2c_f32_bf16 v28, v211, v7
    s_waitcnt vmcnt(6)
    s_cbranch_vccz L_aw75
    s_waitcnt vmcnt(4)
L_aw75:
    buffer_load_dwordx4 v[240:243], v1, s[36:39], s76 offen offset:256 nt
    v_dot2c_f32_bf16 v18, v212, v8
    v_dot2c_f32_bf16 v28, v213, v9
    v_dot2c_f32_bf16 v18, v214, v10
    v_dot2c_f32_bf16 v28, v215, v11
    s_waitcnt vmcnt(6)
    s_cbranch_vccz L_aw76
    s_waitcnt vmcnt(4)
L_aw76:
    s_add_u32 s80, s80, 3
    s_and_b32 s80, s80, 31
    s_mul_i32 s76, s80, 3072
    s_add_u32 s76, s76, 2850816
    buffer_load_dwordx4 v[244:247], v1, s[36:39], s76 offen offset:0 nt
    v_dot2c_f32_bf16 v18, v216, v12
    v_dot2c_f32_bf16 v28, v217, v13
    v_dot2c_f32_bf16 v18, v218, v14
    v_dot2c_f32_bf16 v28, v219, v15
    s_nop 2
    v_add_f32 v18, v18, v28
    s_waitcnt vmcnt(6)
    s_cbranch_vccz L_aw77
    s_waitcnt vmcnt(4)
L_aw77:
    buffer_load_dwordx4 v[248:251], v1, s[36:39], s76 offen offset:128 nt
    v_mov_b32 v19, 0
    v_mov_b32 v28, 0
    v_dot2c_f32_bf16 v19, v220, v4
    v_dot2c_f32_bf16 v28, v221, v5
    v_dot2c_f32_bf16 v19, v222, v6
    v_dot2c_f32_bf16 v28, v223, v7
    s_waitcnt vmcnt(6)
    s_cbranch_vccz L_aw78
    s_waitcnt vmcnt(4)
L_aw78:
    buffer_load_dwordx4 v[252:255], v1, s[36:39], s76 offen offset:256 nt
    v_dot2c_f32_bf16 v19, v224, v8
    v_dot2c_f32_bf16 v28, v225, v9
    v_dot2c_f32_bf16 v19, v226, v10
    v_dot2c_f32_bf16 v28, v227, v11
    s_waitcnt lgkmcnt(0)
    v_cmp_eq_u32 vcc, 0, v64
    v_add_u32 v65, 1, v65
    ds_write_b32 v57, v65 offset:11056
    ds_read_b32 v64, v58 offset:11015
    s_waitcnt vmcnt(6)
    s_cbranch_vccz L_aw79
    s_waitcnt vmcnt(4)
L_aw79:
    s_add_u32 s80, s80, 3
    s_and_b32 s80, s80, 31
    s_mul_i32 s76, s80, 3072
    s_add_u32 s76, s76, 2949120
    buffer_load_dwordx4 v[76:79], v1, s[36:39], s76 offen offset:0 nt
    v_dot2c_f32_bf16 v19, v228, v12
    v_dot2c_f32_bf16 v28, v229, v13
    v_dot2c_f32_bf16 v19, v230, v14
    v_dot2c_f32_bf16 v28, v231, v15
    s_nop 2
    v_add_f32 v19, v19, v28
    s_waitcnt vmcnt(6)
    s_cbranch_vccz L_aw80
    s_waitcnt vmcnt(4)
L_aw80:
    buffer_load_dwordx4 v[80:83], v1, s[36:39], s76 offen offset:128 nt
    v_mov_b32 v20, 0
    v_mov_b32 v28, 0
    v_dot2c_f32_bf16 v20, v232, v4
    v_dot2c_f32_bf16 v28, v233, v5
    v_dot2c_f32_bf16 v20, v234, v6
    v_dot2c_f32_bf16 v28, v235, v7
    s_waitcnt vmcnt(6)
    s_cbranch_vccz L_aw81
    s_waitcnt vmcnt(4)
L_aw81:
    buffer_load_dwordx4 v[84:87], v1, s[36:39], s76 offen offset:256 nt
    v_dot2c_f32_bf16 v20, v236, v8
    v_dot2c_f32_bf16 v28, v237, v9
    v_dot2c_f32_bf16 v20, v238, v10
    v_dot2c_f32_bf16 v28, v239, v11
    s_waitcnt vmcnt(6)
    s_cbranch_vccz L_aw82
    s_waitcnt vmcnt(4)
L_aw82:
    s_add_u32 s80, s80, 3
    s_and_b32 s80, s80, 31
    s_mul_i32 s76, s80, 3072
    s_add_u32 s76, s76, 3047424
    buffer_load_dwordx4 v[88:91], v1, s[36:39], s76 offen offset:0 nt
    v_dot2c_f32_bf16 v20, v240, v12
    v_dot2c_f32_bf16 v28, v241, v13
    v_dot2c_f32_bf16 v20, v242, v14
    v_dot2c_f32_bf16 v28, v243, v15
    s_nop 2
    v_add_f32 v20, v20, v28
    s_waitcnt vmcnt(6)
    s_cbranch_vccz L_aw83
    s_waitcnt vmcnt(4)
L_aw83:
    buffer_load_dwordx4 v[92:95], v1, s[36:39], s76 offen offset:128 nt
    v_mov_b32 v21, 0
    v_mov_b32 v28, 0
    v_dot2c_f32_bf16 v21, v244, v4
    v_dot2c_f32_bf16 v28, v245, v5
    v_dot2c_f32_bf16 v21, v246, v6
    v_dot2c_f32_bf16 v28, v247, v7
    s_waitcnt vmcnt(6)
    s_cbranch_vccz L_aw84
    s_waitcnt vmcnt(4)
L_aw84:
    buffer_load_dwordx4 v[96:99], v1, s[36:39], s76 offen offset:256 nt
    v_dot2c_f32_bf16 v21, v248, v8
    v_dot2c_f32_bf16 v28, v249, v9
    v_dot2c_f32_bf16 v21, v250, v10
    v_dot2c_f32_bf16 v28, v251, v11
    s_waitcnt lgkmcnt(0)
    v_cmp_eq_u32 vcc, 0, v64
    v_add_u32 v65, 1, v65
    ds_write_b32 v57, v65 offset:11056
    ds_read_b32 v64, v58 offset:11015
    s_waitcnt vmcnt(6)
    s_cbranch_vccz L_aw85
    s_waitcnt vmcnt(4)
L_aw85:
    s_mov_b32 s80, s81
    s_mul_i32 s76, s80, 3072
    buffer_load_dwordx4 v[100:103], v1, s[40:43], s76 offen offset:0 nt
    v_dot2c_f32_bf16 v21, v252, v12
    v_dot2c_f32_bf16 v28, v253, v13
    v_dot2c_f32_bf16 v21, v254, v14
    v_dot2c_f32_bf16 v28, v255, v15
    s_nop 2
    v_add_f32 v21, v21, v28
    s_waitcnt vmcnt(6)
    s_cbranch_vccz L_aw86
    s_waitcnt vmcnt(4)
L_aw86:
    buffer_load_dwordx4 v[104:107], v1, s[40:43], s76 offen offset:128 nt
    v_mov_b32 v22, 0
    v_mov_b32 v28, 0
    v_dot2c_f32_bf16 v22, v76, v4
    v_dot2c_f32_bf16 v28, v77, v5
    v_dot2c_f32_bf16 v22, v78, v6
    v_dot2c_f32_bf16 v28, v79, v7
    s_waitcnt vmcnt(6)
    s_cbranch_vccz L_aw87
    s_waitcnt vmcnt(4)
L_aw87:
    buffer_load_dwordx4 v[108:111], v1, s[40:43], s76 offen offset:256 nt
    v_dot2c_f32_bf16 v22, v80, v8
    v_dot2c_f32_bf16 v28, v81, v9
    v_dot2c_f32_bf16 v22, v82, v10
    v_dot2c_f32_bf16 v28, v83, v11
    s_waitcnt vmcnt(6)
    s_cbranch_vccz L_aw88
    s_waitcnt vmcnt(4)
L_aw88:
    s_add_u32 s80, s80, 3
    s_and_b32 s80, s80, 31
    s_mul_i32 s76, s80, 3072
    s_add_u32 s76, s76, 98304
    buffer_load_dwordx4 v[112:115], v1, s[40:43], s76 offen offset:0 nt
    v_dot2c_f32_bf16 v22, v84, v12
    v_dot2c_f32_bf16 v28, v85, v13
    v_dot2c_f32_bf16 v22, v86, v14
    v_dot2c_f32_bf16 v28, v87, v15
    s_nop 2
    v_add_f32 v22, v22, v28
    s_waitcnt vmcnt(6)
    s_cbranch_vccz L_aw89
    s_waitcnt vmcnt(4)
L_aw89:
    buffer_load_dwordx4 v[116:119], v1, s[40:43], s76 offen offset:128 nt
    v_mov_b32 v23, 0
    v_mov_b32 v28, 0
    v_dot2c_f32_bf16 v23, v88, v4
    v_dot2c_f32_bf16 v28, v89, v5
    v_dot2c_f32_bf16 v23, v90, v6
    v_dot2c_f32_bf16 v28, v91, v7
    s_waitcnt vmcnt(6)
    s_cbranch_vccz L_aw90
    s_waitcnt vmcnt(4)
L_aw90:
    buffer_load_dwordx4 v[120:123], v1, s[40:43], s76 offen offset:256 nt
    v_dot2c_f32_bf16 v23, v92, v8
    v_dot2c_f32_bf16 v28, v93, v9
    v_dot2c_f32_bf16 v23, v94, v10
    v_dot2c_f32_bf16 v28, v95, v11
    s_waitcnt lgkmcnt(0)
    v_cmp_eq_u32 vcc, 0, v64
    v_add_u32 v65, 1, v65
    ds_write_b32 v57, v65 offset:11056
    ds_read_b32 v64, v58 offset:11015
    s_waitcnt vmcnt(6)
    s_cbranch_vccz L_aw91
    s_waitcnt vmcnt(4)
L_aw91:
    s_add_u32 s80, s80, 3
    s_and_b32 s80, s80, 31
    s_mul_i32 s76, s80, 3072
    s_add_u32 s76, s76, 196608
    buffer_load_dwordx4 v[124:127], v1, s[40:43], s76 offen offset:0 nt
    v_dot2c_f32_bf16 v23, v96, v12
    v_dot2c_f32_bf16 v28, v97, v13
    v_dot2c_f32_bf16 v23, v98, v14
    v_dot2c_f32_bf16 v28, v99, v15
    s_nop 2
    v_add_f32 v23, v23, v28
    v_add_f32_dpp v16, v16, v16 row_shl:4 row_mask:0xf bank_mask:0x5
    v_add_f32_dpp v17, v17, v17 row_shl:4 row_mask:0xf bank_mask:0x5
    v_add_f32_dpp v18, v18, v18 row_shl:4 row_mask:0xf bank_mask:0x5
    v_add_f32_dpp v19, v19, v19 row_shl:4 row_mask:0xf bank_mask:0x5
    v_add_f32_dpp v16, v20, v20 row_shr:4 row_mask:0xf bank_mask:0xa
    v_add_f32_dpp v17, v21, v21 row_shr:4 row_mask:0xf bank_mask:0xa
    v_add_f32_dpp v18, v22, v22 row_shr:4 row_mask:0xf bank_mask:0xa
    v_add_f32_dpp v19, v23, v23 row_shr:4 row_mask:0xf bank_mask:0xa
    v_add_f32_dpp v16, v16, v16 quad_perm:[2,3,0,1] row_mask:0xf bank_mask:0xf
    v_add_f32_dpp v17, v17, v17 quad_perm:[2,3,0,1] row_mask:0xf bank_mask:0xf
    v_add_f32_dpp v18, v18, v18 quad_perm:[2,3,0,1] row_mask:0xf bank_mask:0xf
    v_add_f32_dpp v19, v19, v19 quad_perm:[2,3,0,1] row_mask:0xf bank_mask:0xf
    v_cndmask_b32 v16, v16, v18, s[10:11]
    v_cndmask_b32 v17, v17, v19, s[10:11]
    s_nop 0
    v_add_f32_dpp v16, v16, v16 quad_perm:[1,0,3,2] row_mask:0xf bank_mask:0xf
    v_add_f32_dpp v17, v17, v17 quad_perm:[1,0,3,2] row_mask:0xf bank_mask:0xf
    v_cndmask_b32 v27, v16, v17, s[8:9]
    s_waitcnt vmcnt(6)
    s_cbranch_vccz L_aw92
    s_waitcnt vmcnt(4)
L_aw92:
    buffer_load_dwordx4 v[128:131], v1, s[40:43], s76 offen offset:128 nt
    v_cvt_pk_bf16_f32 v2, v24, v25
    v_lshlrev_b32 v24, 16, v2
    v_and_b32 v25, 0xffff0000, v2
    v_mul_f32 v24, 0x3d93cd3a, v24
    v_mul_f32 v25, 0x3d93cd3a, v25
    v_cvt_pk_bf16_f32 v2, v24, v25
    v_lshlrev_b32 v24, 16, v2
    v_and_b32 v25, 0xffff0000, v2
    v_cvt_pk_bf16_f32 v2, v26, v27
    v_lshlrev_b32 v26, 16, v2
    v_and_b32 v27, 0xffff0000, v2
    v_mul_f32 v26, 0x3d93cd3a, v26
    v_mul_f32 v27, 0x3d93cd3a, v27
    v_cvt_pk_bf16_f32 v2, v26, v27
    v_lshlrev_b32 v26, 16, v2
    v_and_b32 v27, 0xffff0000, v2
    v_max3_f32 v60, v24, v25, v26
    v_max_f32 v60, v60, v27
    s_waitcnt vmcnt(6)
    s_cbranch_vccz L_aw93
    s_waitcnt vmcnt(4)
L_aw93:
    buffer_load_dwordx4 v[132:135], v1, s[40:43], s76 offen offset:256 nt
    v_mov_b32 v2, v60
    s_nop 1
    v_permlane32_swap_b32 v60, v2
    v_max_f32 v60, v60, v2
    v_mov_b32 v2, v60
    s_nop 1
    v_permlane16_swap_b32 v60, v2
    v_max_f32 v60, v60, v2
    s_nop 1
    v_max_f32_dpp v60, v60, v60 row_ror:8 row_mask:0xf bank_mask:0xf
    s_nop 1
    v_max_f32_dpp v60, v60, v60 row_ror:4 row_mask:0xf bank_mask:0xf
    s_nop 1
    v_max_f32_dpp v60, v60, v60 row_ror:2 row_mask:0xf bank_mask:0xf
    s_nop 1
    v_max_f32_dpp v60, v60, v60 row_ror:1 row_mask:0xf bank_mask:0xf
    s_waitcnt vmcnt(6)
    s_cbranch_vccz L_aw94
    s_waitcnt vmcnt(4)
L_aw94:
    s_add_u32 s80, s80, 3
    s_and_b32 s80, s80, 31
    s_mul_i32 s76, s80, 3072
    s_add_u32 s76, s76, 294912
    buffer_load_dwordx4 v[136:139], v1, s[40:43], s76 offen offset:0 nt
    v_sub_f32 v24, v24, v60
    v_sub_f32 v25, v25, v60
    v_sub_f32 v26, v26, v60
    v_sub_f32 v27, v27, v60
    v_mul_f32 v24, 0x3fb8aa3b, v24
    v_mul_f32 v25, 0x3fb8aa3b, v25
    v_mul_f32 v26, 0x3fb8aa3b, v26
    v_mul_f32 v27, 0x3fb8aa3b, v27
    v_exp_f32 v24, v24
    v_exp_f32 v25, v25
    v_exp_f32 v26, v26
    v_exp_f32 v27, v27
    v_add_f32 v61, v24, v25
    v_add_f32 v2, v26, v27
    v_add_f32 v61, v61, v2
    v_cvt_pk_bf16_f32 v24, v24, 0
    v_cvt_pk_bf16_f32 v25, v25, 0
    v_cvt_pk_bf16_f32 v26, v26, 0
    v_cvt_pk_bf16_f32 v27, v27, 0
    v_mov_b32 v32, 0
    v_mov_b32 v33, 0
    v_mov_b32 v34, 0
    v_mov_b32 v35, 0
    v_mov_b32 v36, 0
    v_mov_b32 v37, 0
    v_mov_b32 v38, 0
    v_mov_b32 v39, 0
    v_mov_b32 v40, 0
    v_mov_b32 v41, 0
    v_mov_b32 v42, 0
    v_mov_b32 v43, 0
    v_mov_b32 v44, 0
    v_mov_b32 v45, 0
    v_mov_b32 v46, 0
    v_mov_b32 v47, 0
    v_mov_b32 v48, 0
    v_mov_b32 v49, 0
    v_mov_b32 v50, 0
    v_mov_b32 v51, 0
    v_mov_b32 v52, 0
    v_mov_b32 v53, 0
    v_mov_b32 v54, 0
    v_mov_b32 v55, 0
    s_waitcnt vmcnt(6)
    s_cbranch_vccz L_aw95
    s_waitcnt vmcnt(4)
L_aw95:
    buffer_load_dwordx4 v[140:143], v1, s[40:43], s76 offen offset:128 nt
    v_mov_b32 v2, v61
    s_nop 1
    v_permlane32_swap_b32 v61, v2
    v_add_f32 v61, v61, v2
    v_mov_b32 v2, v61
    s_nop 1
    v_permlane16_swap_b32 v61, v2
    v_add_f32 v61, v61, v2
    s_nop 1
    v_add_f32_dpp v61, v61, v61 row_ror:8 row_mask:0xf bank_mask:0xf
    s_nop 1
    v_add_f32_dpp v61, v61, v61 row_ror:4 row_mask:0xf bank_mask:0xf
    s_nop 1
    v_add_f32_dpp v61, v61, v61 row_ror:2 row_mask:0xf bank_mask:0xf
    s_nop 1
    v_add_f32_dpp v61, v61, v61 row_ror:1 row_mask:0xf bank_mask:0xf
    buffer_store_dwordx2 v[60:61], v56, s[44:47], 0 offen sc1
    s_waitcnt vmcnt(6)
    s_cbranch_vccz L_aw96
    s_waitcnt vmcnt(4)
L_aw96:
    buffer_load_dwordx4 v[144:147], v1, s[40:43], s76 offen offset:256 nt
    s_lshl_b32 s34, s3, 10
    v_lshl_add_u32 v4, v0, 4, s34
    s_lshl_b32 s35, s6, 2
    v_mov_b32 v5, s35
    s_lshl_b32 s34, s6, 12
    v_lshl_add_u32 v6, v0, 4, s34
    v_lshlrev_b32 v7, 2, v0
    s_mul_i32 s14, s4, 12288
    s_mul_i32 s35, s6, 6144
    s_add_u32 s14, s14, s35
    s_lshl_b32 s35, s5, 8
    s_add_u32 s14, s14, s35
    s_add_u32 s14, s14, 393216
    s_add_u32 s15, s14, 4096
    s_waitcnt lgkmcnt(0)
    v_cmp_eq_u32 vcc, 0, v64
    v_add_u32 v65, 1, v65
    ds_write_b32 v57, v65 offset:11056
    ds_read_b32 v64, v58 offset:11015
    s_waitcnt vmcnt(6)
    s_cbranch_vccz L_aw97
    s_waitcnt vmcnt(4)
L_aw97:
    s_add_u32 s80, s80, 3
    s_and_b32 s80, s80, 31
    s_mul_i32 s76, s80, 3072
    s_add_u32 s76, s76, 393216
    buffer_load_dwordx4 v[148:151], v1, s[40:43], s76 offen offset:0 nt
    v_mov_b32_dpp v28, v24 row_newbcast:0 row_mask:0xf bank_mask:0x3
    s_nop 1
    v_mov_b32_dpp v28, v24 row_newbcast:8 row_mask:0xf bank_mask:0xc
    v_lshlrev_b32 v29, 16, v28
    v_dot2c_f32_bf16 v32, v100, v28
    v_dot2c_f32_bf16 v33, v100, v29
    v_dot2c_f32_bf16 v34, v101, v28
    v_dot2c_f32_bf16 v35, v101, v29
    v_dot2c_f32_bf16 v36, v102, v28
    v_dot2c_f32_bf16 v37, v102, v29
    v_dot2c_f32_bf16 v38, v103, v28
    v_dot2c_f32_bf16 v39, v103, v29
    v_dot2c_f32_bf16 v40, v104, v28
    v_dot2c_f32_bf16 v41, v104, v29
    v_dot2c_f32_bf16 v42, v105, v28
    v_dot2c_f32_bf16 v43, v105, v29
    v_dot2c_f32_bf16 v44, v106, v28
    v_dot2c_f32_bf16 v45, v106, v29
    v_dot2c_f32_bf16 v46, v107, v28
    v_dot2c_f32_bf16 v47, v107, v29
    s_waitcnt vmcnt(6)
    s_cbranch_vccz L_aw98
    s_waitcnt vmcnt(4)
L_aw98:
    buffer_load_dwordx4 v[152:155], v1, s[40:43], s76 offen offset:128 nt
    v_dot2c_f32_bf16 v48, v108, v28
    v_dot2c_f32_bf16 v49, v108, v29
    v_dot2c_f32_bf16 v50, v109, v28
    v_dot2c_f32_bf16 v51, v109, v29
    v_dot2c_f32_bf16 v52, v110, v28
    v_dot2c_f32_bf16 v53, v110, v29
    v_dot2c_f32_bf16 v54, v111, v28
    v_dot2c_f32_bf16 v55, v111, v29
    v_mov_b32_dpp v30, v24 row_newbcast:1 row_mask:0xf bank_mask:0x3
    s_nop 1
    v_mov_b32_dpp v30, v24 row_newbcast:9 row_mask:0xf bank_mask:0xc
    v_lshlrev_b32 v31, 16, v30
    v_dot2c_f32_bf16 v32, v112, v30
    v_dot2c_f32_bf16 v33, v112, v31
    v_dot2c_f32_bf16 v34, v113, v30
    v_dot2c_f32_bf16 v35, v113, v31
    v_dot2c_f32_bf16 v36, v114, v30
    v_dot2c_f32_bf16 v37, v114, v31
    v_dot2c_f32_bf16 v38, v115, v30
    v_dot2c_f32_bf16 v39, v115, v31
    s_waitcnt vmcnt(6)
    s_cbranch_vccz L_aw99
    s_waitcnt vmcnt(4)
L_aw99:
    buffer_load_dwordx4 v[156:159], v1, s[40:43], s76 offen offset:256 nt
    v_dot2c_f32_bf16 v40, v116, v30
    v_dot2c_f32_bf16 v41, v116, v31
    v_dot2c_f32_bf16 v42, v117, v30
    v_dot2c_f32_bf16 v43, v117, v31
    v_dot2c_f32_bf16 v44, v118, v30
    v_dot2c_f32_bf16 v45, v118, v31
    v_dot2c_f32_bf16 v46, v119, v30
    v_dot2c_f32_bf16 v47, v119, v31
    v_dot2c_f32_bf16 v48, v120, v30
    v_dot2c_f32_bf16 v49, v120, v31
    v_dot2c_f32_bf16 v50, v121, v30
    v_dot2c_f32_bf16 v51, v121, v31
    v_dot2c_f32_bf16 v52, v122, v30
    v_dot2c_f32_bf16 v53, v122, v31
    v_dot2c_f32_bf16 v54, v123, v30
    v_dot2c_f32_bf16 v55, v123, v31
    s_waitcnt vmcnt(6)
    s_cbranch_vccz L_aw100
    s_waitcnt vmcnt(4)
L_aw100:
    s_add_u32 s80, s80, 3
    s_and_b32 s80, s80, 31
    s_mul_i32 s76, s80, 3072
    s_add_u32 s76, s76, 491520
    buffer_load_dwordx4 v[160:163], v1, s[40:43], s76 offen offset:0 nt
    v_mov_b32_dpp v28, v24 row_newbcast:2 row_mask:0xf bank_mask:0x3
    s_nop 1
    v_mov_b32_dpp v28, v24 row_newbcast:10 row_mask:0xf bank_mask:0xc
    v_lshlrev_b32 v29, 16, v28
    v_dot2c_f32_bf16 v32, v124, v28
    v_dot2c_f32_bf16 v33, v124, v29
    v_dot2c_f32_bf16 v34, v125, v28
    v_dot2c_f32_bf16 v35, v125, v29
    v_dot2c_f32_bf16 v36, v126, v28
    v_dot2c_f32_bf16 v37, v126, v29
    v_dot2c_f32_bf16 v38, v127, v28
    v_dot2c_f32_bf16 v39, v127, v29
    v_dot2c_f32_bf16 v40, v128, v28
    v_dot2c_f32_bf16 v41, v128, v29
    v_dot2c_f32_bf16 v42, v129, v28
    v_dot2c_f32_bf16 v43, v129, v29
    v_dot2c_f32_bf16 v44, v130, v28
    v_dot2c_f32_bf16 v45, v130, v29
    v_dot2c_f32_bf16 v46, v131, v28
    v_dot2c_f32_bf16 v47, v131, v29
    s_waitcnt vmcnt(6)
    s_cbranch_vccz L_aw101
    s_waitcnt vmcnt(4)
L_aw101:
    buffer_load_dwordx4 v[164:167], v1, s[40:43], s76 offen offset:128 nt
    v_dot2c_f32_bf16 v48, v132, v28
    v_dot2c_f32_bf16 v49, v132, v29
    v_dot2c_f32_bf16 v50, v133, v28
    v_dot2c_f32_bf16 v51, v133, v29
    v_dot2c_f32_bf16 v52, v134, v28
    v_dot2c_f32_bf16 v53, v134, v29
    v_dot2c_f32_bf16 v54, v135, v28
    v_dot2c_f32_bf16 v55, v135, v29
    v_mov_b32_dpp v30, v24 row_newbcast:3 row_mask:0xf bank_mask:0x3
    s_nop 1
    v_mov_b32_dpp v30, v24 row_newbcast:11 row_mask:0xf bank_mask:0xc
    v_lshlrev_b32 v31, 16, v30
    v_dot2c_f32_bf16 v32, v136, v30
    v_dot2c_f32_bf16 v33, v136, v31
    v_dot2c_f32_bf16 v34, v137, v30
    v_dot2c_f32_bf16 v35, v137, v31
    v_dot2c_f32_bf16 v36, v138, v30
    v_dot2c_f32_bf16 v37, v138, v31
    v_dot2c_f32_bf16 v38, v139, v30
    v_dot2c_f32_bf16 v39, v139, v31
    s_waitcnt vmcnt(6)
    s_cbranch_vccz L_aw102
    s_waitcnt vmcnt(4)
L_aw102:
    buffer_load_dwordx4 v[168:171], v1, s[40:43], s76 offen offset:256 nt
    v_dot2c_f32_bf16 v40, v140, v30
    v_dot2c_f32_bf16 v41, v140, v31
    v_dot2c_f32_bf16 v42, v141, v30
    v_dot2c_f32_bf16 v43, v141, v31
    v_dot2c_f32_bf16 v44, v142, v30
    v_dot2c_f32_bf16 v45, v142, v31
    v_dot2c_f32_bf16 v46, v143, v30
    v_dot2c_f32_bf16 v47, v143, v31
    s_waitcnt lgkmcnt(0)
    v_cmp_eq_u32 vcc, 0, v64
    v_add_u32 v65, 1, v65
    ds_write_b32 v57, v65 offset:11056
    ds_read_b32 v64, v58 offset:11015
    s_waitcnt vmcnt(6)
    s_cbranch_vccz L_aw103
    s_waitcnt vmcnt(4)
L_aw103:
    s_add_u32 s80, s80, 3
    s_and_b32 s80, s80, 31
    s_mul_i32 s76, s80, 3072
    s_add_u32 s76, s76, 589824
    buffer_load_dwordx4 v[172:175], v1, s[40:43], s76 offen offset:0 nt
    v_dot2c_f32_bf16 v48, v144, v30
    v_dot2c_f32_bf16 v49, v144, v31
    v_dot2c_f32_bf16 v50, v145, v30
    v_dot2c_f32_bf16 v51, v145, v31
    v_dot2c_f32_bf16 v52, v146, v30
    v_dot2c_f32_bf16 v53, v146, v31
    v_dot2c_f32_bf16 v54, v147, v30
    v_dot2c_f32_bf16 v55, v147, v31
    s_waitcnt vmcnt(6)
    s_cbranch_vccz L_aw104
    s_waitcnt vmcnt(4)
L_aw104:
    buffer_load_dwordx4 v[176:179], v1, s[40:43], s76 offen offset:128 nt
    v_mov_b32_dpp v28, v24 row_newbcast:4 row_mask:0xf bank_mask:0x3
    s_nop 1
    v_mov_b32_dpp v28, v24 row_newbcast:12 row_mask:0xf bank_mask:0xc
    v_lshlrev_b32 v29, 16, v28
    v_dot2c_f32_bf16 v32, v148, v28
    v_dot2c_f32_bf16 v33, v148, v29
    v_dot2c_f32_bf16 v34, v149, v28
    v_dot2c_f32_bf16 v35, v149, v29
    v_dot2c_f32_bf16 v36, v150, v28
    v_dot2c_f32_bf16 v37, v150, v29
    v_dot2c_f32_bf16 v38, v151, v28
    v_dot2c_f32_bf16 v39, v151, v29
    s_waitcnt vmcnt(6)
    s_cbranch_vccz L_aw105
    s_waitcnt vmcnt(4)
L_aw105:
    buffer_load_dwordx4 v[180:183], v1, s[40:43], s76 offen offset:256 nt
    v_dot2c_f32_bf16 v40, v152, v28
    v_dot2c_f32_bf16 v41, v152, v29
    v_dot2c_f32_bf16 v42, v153, v28
    v_dot2c_f32_bf16 v43, v153, v29
    v_dot2c_f32_bf16 v44, v154, v28
    v_dot2c_f32_bf16 v45, v154, v29
    v_dot2c_f32_bf16 v46, v155, v28
    v_dot2c_f32_bf16 v47, v155, v29
    s_waitcnt vmcnt(6)
    s_cbranch_vccz L_aw106
    s_waitcnt vmcnt(4)
L_aw106:
    s_add_u32 s80, s80, 3
    s_and_b32 s80, s80, 31
    s_mul_i32 s76, s80, 3072
    s_add_u32 s76, s76, 688128
    buffer_load_dwordx4 v[184:187], v1, s[40:43], s76 offen offset:0 nt
    v_dot2c_f32_bf16 v48, v156, v28
    v_dot2c_f32_bf16 v49, v156, v29
    v_dot2c_f32_bf16 v50, v157, v28
    v_dot2c_f32_bf16 v51, v157, v29
    v_dot2c_f32_bf16 v52, v158, v28
    v_dot2c_f32_bf16 v53, v158, v29
    v_dot2c_f32_bf16 v54, v159, v28
    v_dot2c_f32_bf16 v55, v159, v29
    s_waitcnt vmcnt(6)
    s_cbranch_vccz L_aw107
    s_waitcnt vmcnt(4)
L_aw107:
    buffer_load_dwordx4 v[188:191], v1, s[40:43], s76 offen offset:128 nt
    v_mov_b32_dpp v30, v24 row_newbcast:5 row_mask:0xf bank_mask:0x3
    s_nop 1
    v_mov_b32_dpp v30, v24 row_newbcast:13 row_mask:0xf bank_mask:0xc
    v_lshlrev_b32 v31, 16, v30
    v_dot2c_f32_bf16 v32, v160, v30
    v_dot2c_f32_bf16 v33, v160, v31
    v_dot2c_f32_bf16 v34, v161, v30
    v_dot2c_f32_bf16 v35, v161, v31
    v_dot2c_f32_bf16 v36, v162, v30
    v_dot2c_f32_bf16 v37, v162, v31
    v_dot2c_f32_bf16 v38, v163, v30
    v_dot2c_f32_bf16 v39, v163, v31
    s_waitcnt vmcnt(6)
    s_cbranch_vccz L_aw108
    s_waitcnt vmcnt(4)
L_aw108:
    buffer_load_dwordx4 v[192:195], v1, s[40:43], s76 offen offset:256 nt
    v_dot2c_f32_bf16 v40, v164, v30
    v_dot2c_f32_bf16 v41, v164, v31
    v_dot2c_f32_bf16 v42, v165, v30
    v_dot2c_f32_bf16 v43, v165, v31
    v_dot2c_f32_bf16 v44, v166, v30
    v_dot2c_f32_bf16 v45, v166, v31
    v_dot2c_f32_bf16 v46, v167, v30
    v_dot2c_f32_bf16 v47, v167, v31
    s_waitcnt lgkmcnt(0)
    v_cmp_eq_u32 vcc, 0, v64
    v_add_u32 v65, 1, v65
    ds_write_b32 v57, v65 offset:11056
    ds_read_b32 v64, v58 offset:11015
    s_waitcnt vmcnt(6)
    s_cbranch_vccz L_aw109
    s_waitcnt vmcnt(4)
L_aw109:
    s_add_u32 s80, s80, 3
    s_and_b32 s80, s80, 31
    s_mul_i32 s76, s80, 3072
    s_add_u32 s76, s76, 786432
    buffer_load_dwordx4 v[196:199], v1, s[40:43], s76 offen offset:0 nt
    v_dot2c_f32_bf16 v48, v168, v30
    v_dot2c_f32_bf16 v49, v168, v31
    v_dot2c_f32_bf16 v50, v169, v30
    v_dot2c_f32_bf16 v51, v169, v31
    v_dot2c_f32_bf16 v52, v170, v30
    v_dot2c_f32_bf16 v53, v170, v31
    v_dot2c_f32_bf16 v54, v171, v30
    v_dot2c_f32_bf16 v55, v171, v31
    s_waitcnt vmcnt(6)
    s_cbranch_vccz L_aw110
    s_waitcnt vmcnt(4)
L_aw110:
    buffer_load_dwordx4 v[200:203], v1, s[40:43], s76 offen offset:128 nt
    v_mov_b32_dpp v28, v24 row_newbcast:6 row_mask:0xf bank_mask:0x3
    s_nop 1
    v_mov_b32_dpp v28, v24 row_newbcast:14 row_mask:0xf bank_mask:0xc
    v_lshlrev_b32 v29, 16, v28
    v_dot2c_f32_bf16 v32, v172, v28
    v_dot2c_f32_bf16 v33, v172, v29
    v_dot2c_f32_bf16 v34, v173, v28
    v_dot2c_f32_bf16 v35, v173, v29
    v_dot2c_f32_bf16 v36, v174, v28
    v_dot2c_f32_bf16 v37, v174, v29
    v_dot2c_f32_bf16 v38, v175, v28
    v_dot2c_f32_bf16 v39, v175, v29
    s_waitcnt vmcnt(6)
    s_cbranch_vccz L_aw111
    s_waitcnt vmcnt(4)
L_aw111:
    buffer_load_dwordx4 v[204:207], v1, s[40:43], s76 offen offset:256 nt
    v_dot2c_f32_bf16 v40, v176, v28
    v_dot2c_f32_bf16 v41, v176, v29
    v_dot2c_f32_bf16 v42, v177, v28
    v_dot2c_f32_bf16 v43, v177, v29
    v_dot2c_f32_bf16 v44, v178, v28
    v_dot2c_f32_bf16 v45, v178, v29
    v_dot2c_f32_bf16 v46, v179, v28
    v_dot2c_f32_bf16 v47, v179, v29
    s_waitcnt vmcnt(6)
    s_cbranch_vccz L_aw112
    s_waitcnt vmcnt(4)
L_aw112:
    s_add_u32 s80, s80, 3
    s_and_b32 s80, s80, 31
    s_mul_i32 s76, s80, 3072
    s_add_u32 s76, s76, 884736
    buffer_load_dwordx4 v[208:211], v1, s[40:43], s76 offen offset:0 nt
    v_dot2c_f32_bf16 v48, v180, v28
    v_dot2c_f32_bf16 v49, v180, v29
    v_dot2c_f32_bf16 v50, v181, v28
    v_dot2c_f32_bf16 v51, v181, v29
    v_dot2c_f32_bf16 v52, v182, v28
    v_dot2c_f32_bf16 v53, v182, v29
    v_dot2c_f32_bf16 v54, v183, v28
    v_dot2c_f32_bf16 v55, v183, v29
    s_waitcnt vmcnt(6)
    s_cbranch_vccz L_aw113
    s_waitcnt vmcnt(4)
L_aw113:
    buffer_load_dwordx4 v[212:215], v1, s[40:43], s76 offen offset:128 nt
    v_mov_b32_dpp v30, v24 row_newbcast:7 row_mask:0xf bank_mask:0x3
    s_nop 1
    v_mov_b32_dpp v30, v24 row_newbcast:15 row_mask:0xf bank_mask:0xc
    v_lshlrev_b32 v31, 16, v30
    v_dot2c_f32_bf16 v32, v184, v30
    v_dot2c_f32_bf16 v33, v184, v31
    v_dot2c_f32_bf16 v34, v185, v30
    v_dot2c_f32_bf16 v35, v185, v31
    v_dot2c_f32_bf16 v36, v186, v30
    v_dot2c_f32_bf16 v37, v186, v31
    v_dot2c_f32_bf16 v38, v187, v30
    v_dot2c_f32_bf16 v39, v187, v31
    s_waitcnt vmcnt(6)
    s_cbranch_vccz L_aw114
    s_waitcnt vmcnt(4)
L_aw114:
    buffer_load_dwordx4 v[216:219], v1, s[40:43], s76 offen offset:256 nt
    v_dot2c_f32_bf16 v40, v188, v30
    v_dot2c_f32_bf16 v41, v188, v31
    v_dot2c_f32_bf16 v42, v189, v30
    v_dot2c_f32_bf16 v43, v189, v31
    v_dot2c_f32_bf16 v44, v190, v30
    v_dot2c_f32_bf16 v45, v190, v31
    v_dot2c_f32_bf16 v46, v191, v30
    v_dot2c_f32_bf16 v47, v191, v31
    s_waitcnt lgkmcnt(0)
    v_cmp_eq_u32 vcc, 0, v64
    v_add_u32 v65, 1, v65
    ds_write_b32 v57, v65 offset:11056
    ds_read_b32 v64, v58 offset:11015
    s_waitcnt vmcnt(6)
    s_cbranch_vccz L_aw115
    s_waitcnt vmcnt(4)
L_aw115:
    s_add_u32 s80, s80, 3
    s_and_b32 s80, s80, 31
    s_mul_i32 s76, s80, 3072
    s_add_u32 s76, s76, 983040
    buffer_load_dwordx4 v[220:223], v1, s[40:43], s76 offen offset:0 nt
    v_dot2c_f32_bf16 v48, v192, v30
    v_dot2c_f32_bf16 v49, v192, v31
    v_dot2c_f32_bf16 v50, v193, v30
    v_dot2c_f32_bf16 v51, v193, v31
    v_dot2c_f32_bf16 v52, v194, v30
    v_dot2c_f32_bf16 v53, v194, v31
    v_dot2c_f32_bf16 v54, v195, v30
    v_dot2c_f32_bf16 v55, v195, v31
    s_waitcnt vmcnt(6)
    s_cbranch_vccz L_aw116
    s_waitcnt vmcnt(4)
L_aw116:
    buffer_load_dwordx4 v[224:227], v1, s[40:43], s76 offen offset:128 nt
    v_mov_b32_dpp v28, v25 row_newbcast:0 row_mask:0xf bank_mask:0x3
    s_nop 1
    v_mov_b32_dpp v28, v25 row_newbcast:8 row_mask:0xf bank_mask:0xc
    v_lshlrev_b32 v29, 16, v28
    v_dot2c_f32_bf16 v32, v196, v28
    v_dot2c_f32_bf16 v33, v196, v29
    v_dot2c_f32_bf16 v34, v197, v28
    v_dot2c_f32_bf16 v35, v197, v29
    v_dot2c_f32_bf16 v36, v198, v28
    v_dot2c_f32_bf16 v37, v198, v29
    v_dot2c_f32_bf16 v38, v199, v28
    v_dot2c_f32_bf16 v39, v199, v29
    s_waitcnt vmcnt(6)
    s_cbranch_vccz L_aw117
    s_waitcnt vmcnt(4)
L_aw117:
    buffer_load_dwordx4 v[228:231], v1, s[40:43], s76 offen offset:256 nt
    v_dot2c_f32_bf16 v40, v200, v28
    v_dot2c_f32_bf16 v41, v200, v29
    v_dot2c_f32_bf16 v42, v201, v28
    v_dot2c_f32_bf16 v43, v201, v29
    v_dot2c_f32_bf16 v44, v202, v28
    v_dot2c_f32_bf16 v45, v202, v29
    v_dot2c_f32_bf16 v46, v203, v28
    v_dot2c_f32_bf16 v47, v203, v29
    s_waitcnt vmcnt(6)
    s_cbranch_vccz L_aw118
    s_waitcnt vmcnt(4)
L_aw118:
    s_add_u32 s80, s80, 3
    s_and_b32 s80, s80, 31
    s_mul_i32 s76, s80, 3072
    s_add_u32 s76, s76, 1081344
    buffer_load_dwordx4 v[232:235], v1, s[40:43], s76 offen offset:0 nt
    v_dot2c_f32_bf16 v48, v204, v28
    v_dot2c_f32_bf16 v49, v204, v29
    v_dot2c_f32_bf16 v50, v205, v28
    v_dot2c_f32_bf16 v51, v205, v29
    v_dot2c_f32_bf16 v52, v206, v28
    v_dot2c_f32_bf16 v53, v206, v29
    v_dot2c_f32_bf16 v54, v207, v28
    v_dot2c_f32_bf16 v55, v207, v29
    s_waitcnt vmcnt(6)
    s_cbranch_vccz L_aw119
    s_waitcnt vmcnt(4)
L_aw119:
    buffer_load_dwordx4 v[236:239], v1, s[40:43], s76 offen offset:128 nt
    v_mov_b32_dpp v30, v25 row_newbcast:1 row_mask:0xf bank_mask:0x3
    s_nop 1
    v_mov_b32_dpp v30, v25 row_newbcast:9 row_mask:0xf bank_mask:0xc
    v_lshlrev_b32 v31, 16, v30
    v_dot2c_f32_bf16 v32, v208, v30
    v_dot2c_f32_bf16 v33, v208, v31
    v_dot2c_f32_bf16 v34, v209, v30
    v_dot2c_f32_bf16 v35, v209, v31
    v_dot2c_f32_bf16 v36, v210, v30
    v_dot2c_f32_bf16 v37, v210, v31
    v_dot2c_f32_bf16 v38, v211, v30
    v_dot2c_f32_bf16 v39, v211, v31
    s_waitcnt vmcnt(6)
    s_cbranch_vccz L_aw120
    s_waitcnt vmcnt(4)
L_aw120:
    buffer_load_dwordx4 v[240:243], v1, s[40:43], s76 offen offset:256 nt
    v_dot2c_f32_bf16 v40, v212, v30
    v_dot2c_f32_bf16 v41, v212, v31
    v_dot2c_f32_bf16 v42, v213, v30
    v_dot2c_f32_bf16 v43, v213, v31
    v_dot2c_f32_bf16 v44, v214, v30
    v_dot2c_f32_bf16 v45, v214, v31
    v_dot2c_f32_bf16 v46, v215, v30
    v_dot2c_f32_bf16 v47, v215, v31
    s_waitcnt lgkmcnt(0)
    v_cmp_eq_u32 vcc, 0, v64
    v_add_u32 v65, 1, v65
    ds_write_b32 v57, v65 offset:11056
    ds_read_b32 v64, v58 offset:11015
    s_waitcnt vmcnt(6)
    s_cbranch_vccz L_aw121
    s_waitcnt vmcnt(4)
L_aw121:
    s_add_u32 s80, s80, 3
    s_and_b32 s80, s80, 31
    s_mul_i32 s76, s80, 3072
    s_add_u32 s76, s76, 1179648
    buffer_load_dwordx4 v[244:247], v1, s[40:43], s76 offen offset:0 nt
    v_dot2c_f32_bf16 v48, v216, v30
    v_dot2c_f32_bf16 v49, v216, v31
    v_dot2c_f32_bf16 v50, v217, v30
    v_dot2c_f32_bf16 v51, v217, v31
    v_dot2c_f32_bf16 v52, v218, v30
    v_dot2c_f32_bf16 v53, v218, v31
    v_dot2c_f32_bf16 v54, v219, v30
    v_dot2c_f32_bf16 v55, v219, v31
    s_waitcnt vmcnt(6)
    s_cbranch_vccz L_aw122
    s_waitcnt vmcnt(4)
L_aw122:
    buffer_load_dwordx4 v[248:251], v1, s[40:43], s76 offen offset:128 nt
    v_mov_b32_dpp v28, v25 row_newbcast:2 row_mask:0xf bank_mask:0x3
    s_nop 1
    v_mov_b32_dpp v28, v25 row_newbcast:10 row_mask:0xf bank_mask:0xc
    v_lshlrev_b32 v29, 16, v28
    v_dot2c_f32_bf16 v32, v220, v28
    v_dot2c_f32_bf16 v33, v220, v29
    v_dot2c_f32_bf16 v34, v221, v28
    v_dot2c_f32_bf16 v35, v221, v29
    v_dot2c_f32_bf16 v36, v222, v28
    v_dot2c_f32_bf16 v37, v222, v29
    v_dot2c_f32_bf16 v38, v223, v28
    v_dot2c_f32_bf16 v39, v223, v29
    s_waitcnt vmcnt(6)
    s_cbranch_vccz L_aw123
    s_waitcnt vmcnt(4)
L_aw123:
    buffer_load_dwordx4 v[252:255], v1, s[40:43], s76 offen offset:256 nt
    v_dot2c_f32_bf16 v40, v224, v28
    v_dot2c_f32_bf16 v41, v224, v29
    v_dot2c_f32_bf16 v42, v225, v28
    v_dot2c_f32_bf16 v43, v225, v29
    v_dot2c_f32_bf16 v44, v226, v28
    v_dot2c_f32_bf16 v45, v226, v29
    v_dot2c_f32_bf16 v46, v227, v28
    v_dot2c_f32_bf16 v47, v227, v29
    s_waitcnt vmcnt(6)
    s_cbranch_vccz L_aw124
    s_waitcnt vmcnt(4)
L_aw124:
    s_add_u32 s80, s80, 3
    s_and_b32 s80, s80, 31
    s_mul_i32 s76, s80, 3072
    s_add_u32 s76, s76, 1277952
    buffer_load_dwordx4 v[76:79], v1, s[40:43], s76 offen offset:0 nt
    v_dot2c_f32_bf16 v48, v228, v28
    v_dot2c_f32_bf16 v49, v228, v29
    v_dot2c_f32_bf16 v50, v229, v28
    v_dot2c_f32_bf16 v51, v229, v29
    v_dot2c_f32_bf16 v52, v230, v28
    v_dot2c_f32_bf16 v53, v230, v29
    v_dot2c_f32_bf16 v54, v231, v28
    v_dot2c_f32_bf16 v55, v231, v29
    s_waitcnt vmcnt(6)
    s_cbranch_vccz L_aw125
    s_waitcnt vmcnt(4)
L_aw125:
    buffer_load_dwordx4 v[80:83], v1, s[40:43], s76 offen offset:128 nt
    v_mov_b32_dpp v30, v25 row_newbcast:3 row_mask:0xf bank_mask:0x3
    s_nop 1
    v_mov_b32_dpp v30, v25 row_newbcast:11 row_mask:0xf bank_mask:0xc
    v_lshlrev_b32 v31, 16, v30
    v_dot2c_f32_bf16 v32, v232, v30
    v_dot2c_f32_bf16 v33, v232, v31
    v_dot2c_f32_bf16 v34, v233, v30
    v_dot2c_f32_bf16 v35, v233, v31
    v_dot2c_f32_bf16 v36, v234, v30
    v_dot2c_f32_bf16 v37, v234, v31
    v_dot2c_f32_bf16 v38, v235, v30
    v_dot2c_f32_bf16 v39, v235, v31
    s_waitcnt vmcnt(6)
    s_cbranch_vccz L_aw126
    s_waitcnt vmcnt(4)
L_aw126:
    buffer_load_dwordx4 v[84:87], v1, s[40:43], s76 offen offset:256 nt
    v_dot2c_f32_bf16 v40, v236, v30
    v_dot2c_f32_bf16 v41, v236, v31
    v_dot2c_f32_bf16 v42, v237, v30
    v_dot2c_f32_bf16 v43, v237, v31
    v_dot2c_f32_bf16 v44, v238, v30
    v_dot2c_f32_bf16 v45, v238, v31
    v_dot2c_f32_bf16 v46, v239, v30
    v_dot2c_f32_bf16 v47, v239, v31
    s_waitcnt lgkmcnt(0)
    v_cmp_eq_u32 vcc, 0, v64
    v_add_u32 v65, 1, v65
    ds_write_b32 v57, v65 offset:11056
    ds_read_b32 v64, v58 offset:11015
    s_waitcnt vmcnt(6)
    s_cbranch_vccz L_aw127
    s_waitcnt vmcnt(4)
L_aw127:
    s_add_u32 s80, s80, 3
    s_and_b32 s80, s80, 31
    s_mul_i32 s76, s80, 3072
    s_add_u32 s76, s76, 1376256
    buffer_load_dwordx4 v[88:91], v1, s[40:43], s76 offen offset:0 nt
    v_dot2c_f32_bf16 v48, v240, v30
    v_dot2c_f32_bf16 v49, v240, v31
    v_dot2c_f32_bf16 v50, v241, v30
    v_dot2c_f32_bf16 v51, v241, v31
    v_dot2c_f32_bf16 v52, v242, v30
    v_dot2c_f32_bf16 v53, v242, v31
    v_dot2c_f32_bf16 v54, v243, v30
    v_dot2c_f32_bf16 v55, v243, v31
    s_waitcnt vmcnt(6)
    s_cbranch_vccz L_aw128
    s_waitcnt vmcnt(4)
L_aw128:
    buffer_load_dwordx4 v[92:95], v1, s[40:43], s76 offen offset:128 nt
    v_mov_b32_dpp v28, v25 row_newbcast:4 row_mask:0xf bank_mask:0x3
    s_nop 1
    v_mov_b32_dpp v28, v25 row_newbcast:12 row_mask:0xf bank_mask:0xc
    v_lshlrev_b32 v29, 16, v28
    v_dot2c_f32_bf16 v32, v244, v28
    v_dot2c_f32_bf16 v33, v244, v29
    v_dot2c_f32_bf16 v34, v245, v28
    v_dot2c_f32_bf16 v35, v245, v29
    v_dot2c_f32_bf16 v36, v246, v28
    v_dot2c_f32_bf16 v37, v246, v29
    v_dot2c_f32_bf16 v38, v247, v28
    v_dot2c_f32_bf16 v39, v247, v29
    s_waitcnt vmcnt(6)
    s_cbranch_vccz L_aw129
    s_waitcnt vmcnt(4)
L_aw129:
    buffer_load_dwordx4 v[96:99], v1, s[40:43], s76 offen offset:256 nt
    v_dot2c_f32_bf16 v40, v248, v28
    v_dot2c_f32_bf16 v41, v248, v29
    v_dot2c_f32_bf16 v42, v249, v28
    v_dot2c_f32_bf16 v43, v249, v29
    v_dot2c_f32_bf16 v44, v250, v28
    v_dot2c_f32_bf16 v45, v250, v29
    v_dot2c_f32_bf16 v46, v251, v28
    v_dot2c_f32_bf16 v47, v251, v29
    s_waitcnt vmcnt(6)
    s_cbranch_vccz L_aw130
    s_waitcnt vmcnt(4)
L_aw130:
    s_add_u32 s80, s80, 3
    s_and_b32 s80, s80, 31
    s_mul_i32 s76, s80, 3072
    s_add_u32 s76, s76, 1474560
    buffer_load_dwordx4 v[100:103], v1, s[40:43], s76 offen offset:0 nt
    v_dot2c_f32_bf16 v48, v252, v28
    v_dot2c_f32_bf16 v49, v252, v29
    v_dot2c_f32_bf16 v50, v253, v28
    v_dot2c_f32_bf16 v51, v253, v29
    v_dot2c_f32_bf16 v52, v254, v28
    v_dot2c_f32_bf16 v53, v254, v29
    v_dot2c_f32_bf16 v54, v255, v28
    v_dot2c_f32_bf16 v55, v255, v29
    s_waitcnt vmcnt(6)
    s_cbranch_vccz L_aw131
    s_waitcnt vmcnt(4)
L_aw131:
    buffer_load_dwordx4 v[104:107], v1, s[40:43], s76 offen offset:128 nt
    v_mov_b32_dpp v30, v25 row_newbcast:5 row_mask:0xf bank_mask:0x3
    s_nop 1
    v_mov_b32_dpp v30, v25 row_newbcast:13 row_mask:0xf bank_mask:0xc
    v_lshlrev_b32 v31, 16, v30
    v_dot2c_f32_bf16 v32, v76, v30
    v_dot2c_f32_bf16 v33, v76, v31
    v_dot2c_f32_bf16 v34, v77, v30
    v_dot2c_f32_bf16 v35, v77, v31
    v_dot2c_f32_bf16 v36, v78, v30
    v_dot2c_f32_bf16 v37, v78, v31
    v_dot2c_f32_bf16 v38, v79, v30
    v_dot2c_f32_bf16 v39, v79, v31
    s_waitcnt vmcnt(6)
    s_cbranch_vccz L_aw132
    s_waitcnt vmcnt(4)
L_aw132:
    buffer_load_dwordx4 v[108:111], v1, s[40:43], s76 offen offset:256 nt
    v_dot2c_f32_bf16 v40, v80, v30
    v_dot2c_f32_bf16 v41, v80, v31
    v_dot2c_f32_bf16 v42, v81, v30
    v_dot2c_f32_bf16 v43, v81, v31
    v_dot2c_f32_bf16 v44, v82, v30
    v_dot2c_f32_bf16 v45, v82, v31
    v_dot2c_f32_bf16 v46, v83, v30
    v_dot2c_f32_bf16 v47, v83, v31
    s_waitcnt lgkmcnt(0)
    v_cmp_eq_u32 vcc, 0, v64
    v_add_u32 v65, 1, v65
    ds_write_b32 v57, v65 offset:11056
    ds_read_b32 v64, v58 offset:11015
    s_waitcnt vmcnt(6)
    s_cbranch_vccz L_aw133
    s_waitcnt vmcnt(4)
L_aw133:
    s_add_u32 s80, s80, 3
    s_and_b32 s80, s80, 31
    s_mul_i32 s76, s80, 3072
    s_add_u32 s76, s76, 1572864
    buffer_load_dwordx4 v[112:115], v1, s[40:43], s76 offen offset:0 nt
    v_dot2c_f32_bf16 v48, v84, v30
    v_dot2c_f32_bf16 v49, v84, v31
    v_dot2c_f32_bf16 v50, v85, v30
    v_dot2c_f32_bf16 v51, v85, v31
    v_dot2c_f32_bf16 v52, v86, v30
    v_dot2c_f32_bf16 v53, v86, v31
    v_dot2c_f32_bf16 v54, v87, v30
    v_dot2c_f32_bf16 v55, v87, v31
    s_waitcnt vmcnt(6)
    s_cbranch_vccz L_aw134
    s_waitcnt vmcnt(4)
L_aw134:
    buffer_load_dwordx4 v[116:119], v1, s[40:43], s76 offen offset:128 nt
    v_mov_b32_dpp v28, v25 row_newbcast:6 row_mask:0xf bank_mask:0x3
    s_nop 1
    v_mov_b32_dpp v28, v25 row_newbcast:14 row_mask:0xf bank_mask:0xc
    v_lshlrev_b32 v29, 16, v28
    v_dot2c_f32_bf16 v32, v88, v28
    v_dot2c_f32_bf16 v33, v88, v29
    v_dot2c_f32_bf16 v34, v89, v28
    v_dot2c_f32_bf16 v35, v89, v29
    v_dot2c_f32_bf16 v36, v90, v28
    v_dot2c_f32_bf16 v37, v90, v29
    v_dot2c_f32_bf16 v38, v91, v28
    v_dot2c_f32_bf16 v39, v91, v29
    s_waitcnt vmcnt(6)
    s_cbranch_vccz L_aw135
    s_waitcnt vmcnt(4)
L_aw135:
    buffer_load_dwordx4 v[120:123], v1, s[40:43], s76 offen offset:256 nt
    v_dot2c_f32_bf16 v40, v92, v28
    v_dot2c_f32_bf16 v41, v92, v29
    v_dot2c_f32_bf16 v42, v93, v28
    v_dot2c_f32_bf16 v43, v93, v29
    v_dot2c_f32_bf16 v44, v94, v28
    v_dot2c_f32_bf16 v45, v94, v29
    v_dot2c_f32_bf16 v46, v95, v28
    v_dot2c_f32_bf16 v47, v95, v29
    s_waitcnt vmcnt(6)
    s_cbranch_vccz L_aw136
    s_waitcnt vmcnt(4)
L_aw136:
    s_add_u32 s80, s80, 3
    s_and_b32 s80, s80, 31
    s_mul_i32 s76, s80, 3072
    s_add_u32 s76, s76, 1671168
    buffer_load_dwordx4 v[124:127], v1, s[40:43], s76 offen offset:0 nt
    v_dot2c_f32_bf16 v48, v96, v28
    v_dot2c_f32_bf16 v49, v96, v29
    v_dot2c_f32_bf16 v50, v97, v28
    v_dot2c_f32_bf16 v51, v97, v29
    v_dot2c_f32_bf16 v52, v98, v28
    v_dot2c_f32_bf16 v53, v98, v29
    v_dot2c_f32_bf16 v54, v99, v28
    v_dot2c_f32_bf16 v55, v99, v29
    s_waitcnt vmcnt(6)
    s_cbranch_vccz L_aw137
    s_waitcnt vmcnt(4)
L_aw137:
    buffer_load_dwordx4 v[128:131], v1, s[40:43], s76 offen offset:128 nt
    v_mov_b32_dpp v30, v25 row_newbcast:7 row_mask:0xf bank_mask:0x3
    s_nop 1
    v_mov_b32_dpp v30, v25 row_newbcast:15 row_mask:0xf bank_mask:0xc
    v_lshlrev_b32 v31, 16, v30
    v_dot2c_f32_bf16 v32, v100, v30
    v_dot2c_f32_bf16 v33, v100, v31
    v_dot2c_f32_bf16 v34, v101, v30
    v_dot2c_f32_bf16 v35, v101, v31
    v_dot2c_f32_bf16 v36, v102, v30
    v_dot2c_f32_bf16 v37, v102, v31
    v_dot2c_f32_bf16 v38, v103, v30
    v_dot2c_f32_bf16 v39, v103, v31
    s_waitcnt vmcnt(6)
    s_cbranch_vccz L_aw138
    s_waitcnt vmcnt(4)
L_aw138:
    buffer_load_dwordx4 v[132:135], v1, s[40:43], s76 offen offset:256 nt
    v_dot2c_f32_bf16 v40, v104, v30
    v_dot2c_f32_bf16 v41, v104, v31
    v_dot2c_f32_bf16 v42, v105, v30
    v_dot2c_f32_bf16 v43, v105, v31
    v_dot2c_f32_bf16 v44, v106, v30
    v_dot2c_f32_bf16 v45, v106, v31
    v_dot2c_f32_bf16 v46, v107, v30
    v_dot2c_f32_bf16 v47, v107, v31
    s_waitcnt lgkmcnt(0)
    v_cmp_eq_u32 vcc, 0, v64
    v_add_u32 v65, 1, v65
    ds_write_b32 v57, v65 offset:11056
    ds_read_b32 v64, v58 offset:11015
    s_waitcnt vmcnt(6)
    s_cbranch_vccz L_aw139
    s_waitcnt vmcnt(4)
L_aw139:
    s_add_u32 s80, s80, 3
    s_and_b32 s80, s80, 31
    s_mul_i32 s76, s80, 3072
    s_add_u32 s76, s76, 1769472
    buffer_load_dwordx4 v[136:139], v1, s[40:43], s76 offen offset:0 nt
    v_dot2c_f32_bf16 v48, v108, v30
    v_dot2c_f32_bf16 v49, v108, v31
    v_dot2c_f32_bf16 v50, v109, v30
    v_dot2c_f32_bf16 v51, v109, v31
    v_dot2c_f32_bf16 v52, v110, v30
    v_dot2c_f32_bf16 v53, v110, v31
    v_dot2c_f32_bf16 v54, v111, v30
    v_dot2c_f32_bf16 v55, v111, v31
    s_waitcnt vmcnt(6)
    s_cbranch_vccz L_aw140
    s_waitcnt vmcnt(4)
L_aw140:
    buffer_load_dwordx4 v[140:143], v1, s[40:43], s76 offen offset:128 nt
    v_mov_b32_dpp v28, v26 row_newbcast:0 row_mask:0xf bank_mask:0x3
    s_nop 1
    v_mov_b32_dpp v28, v26 row_newbcast:8 row_mask:0xf bank_mask:0xc
    v_lshlrev_b32 v29, 16, v28
    v_dot2c_f32_bf16 v32, v112, v28
    v_dot2c_f32_bf16 v33, v112, v29
    v_dot2c_f32_bf16 v34, v113, v28
    v_dot2c_f32_bf16 v35, v113, v29
    v_dot2c_f32_bf16 v36, v114, v28
    v_dot2c_f32_bf16 v37, v114, v29
    v_dot2c_f32_bf16 v38, v115, v28
    v_dot2c_f32_bf16 v39, v115, v29
    s_waitcnt vmcnt(6)
    s_cbranch_vccz L_aw141
    s_waitcnt vmcnt(4)
L_aw141:
    buffer_load_dwordx4 v[144:147], v1, s[40:43], s76 offen offset:256 nt
    v_dot2c_f32_bf16 v40, v116, v28
    v_dot2c_f32_bf16 v41, v116, v29
    v_dot2c_f32_bf16 v42, v117, v28
    v_dot2c_f32_bf16 v43, v117, v29
    v_dot2c_f32_bf16 v44, v118, v28
    v_dot2c_f32_bf16 v45, v118, v29
    v_dot2c_f32_bf16 v46, v119, v28
    v_dot2c_f32_bf16 v47, v119, v29
    s_waitcnt vmcnt(6)
    s_cbranch_vccz L_aw142
    s_waitcnt vmcnt(4)
L_aw142:
    s_add_u32 s80, s80, 3
    s_and_b32 s80, s80, 31
    s_mul_i32 s76, s80, 3072
    s_add_u32 s76, s76, 1867776
    buffer_load_dwordx4 v[148:151], v1, s[40:43], s76 offen offset:0 nt
    v_dot2c_f32_bf16 v48, v120, v28
    v_dot2c_f32_bf16 v49, v120, v29
    v_dot2c_f32_bf16 v50, v121, v28
    v_dot2c_f32_bf16 v51, v121, v29
    v_dot2c_f32_bf16 v52, v122, v28
    v_dot2c_f32_bf16 v53, v122, v29
    v_dot2c_f32_bf16 v54, v123, v28
    v_dot2c_f32_bf16 v55, v123, v29
    s_waitcnt vmcnt(6)
    s_cbranch_vccz L_aw143
    s_waitcnt vmcnt(4)
L_aw143:
    buffer_load_dwordx4 v[152:155], v1, s[40:43], s76 offen offset:128 nt
    v_mov_b32_dpp v30, v26 row_newbcast:1 row_mask:0xf bank_mask:0x3
    s_nop 1
    v_mov_b32_dpp v30, v26 row_newbcast:9 row_mask:0xf bank_mask:0xc
    v_lshlrev_b32 v31, 16, v30
    v_dot2c_f32_bf16 v32, v124, v30
    v_dot2c_f32_bf16 v33, v124, v31
    v_dot2c_f32_bf16 v34, v125, v30
    v_dot2c_f32_bf16 v35, v125, v31
    v_dot2c_f32_bf16 v36, v126, v30
    v_dot2c_f32_bf16 v37, v126, v31
    v_dot2c_f32_bf16 v38, v127, v30
    v_dot2c_f32_bf16 v39, v127, v31
    s_waitcnt vmcnt(6)
    s_cbranch_vccz L_aw144
    s_waitcnt vmcnt(4)
L_aw144:
    buffer_load_dwordx4 v[156:159], v1, s[40:43], s76 offen offset:256 nt
    v_dot2c_f32_bf16 v40, v128, v30
    v_dot2c_f32_bf16 v41, v128, v31
    v_dot2c_f32_bf16 v42, v129, v30
    v_dot2c_f32_bf16 v43, v129, v31
    v_dot2c_f32_bf16 v44, v130, v30
    v_dot2c_f32_bf16 v45, v130, v31
    v_dot2c_f32_bf16 v46, v131, v30
    v_dot2c_f32_bf16 v47, v131, v31
    s_waitcnt lgkmcnt(0)
    v_cmp_eq_u32 vcc, 0, v64
    v_add_u32 v65, 1, v65
    ds_write_b32 v57, v65 offset:11056
    ds_read_b32 v64, v58 offset:11015
    s_waitcnt vmcnt(6)
    s_cbranch_vccz L_aw145
    s_waitcnt vmcnt(4)
L_aw145:
    s_add_u32 s80, s80, 3
    s_and_b32 s80, s80, 31
    s_mul_i32 s76, s80, 3072
    s_add_u32 s76, s76, 1966080
    buffer_load_dwordx4 v[160:163], v1, s[40:43], s76 offen offset:0 nt
    v_dot2c_f32_bf16 v48, v132, v30
    v_dot2c_f32_bf16 v49, v132, v31
    v_dot2c_f32_bf16 v50, v133, v30
    v_dot2c_f32_bf16 v51, v133, v31
    v_dot2c_f32_bf16 v52, v134, v30
    v_dot2c_f32_bf16 v53, v134, v31
    v_dot2c_f32_bf16 v54, v135, v30
    v_dot2c_f32_bf16 v55, v135, v31
    s_waitcnt vmcnt(6)
    s_cbranch_vccz L_aw146
    s_waitcnt vmcnt(4)
L_aw146:
    buffer_load_dwordx4 v[164:167], v1, s[40:43], s76 offen offset:128 nt
    v_mov_b32_dpp v28, v26 row_newbcast:2 row_mask:0xf bank_mask:0x3
    s_nop 1
    v_mov_b32_dpp v28, v26 row_newbcast:10 row_mask:0xf bank_mask:0xc
    v_lshlrev_b32 v29, 16, v28
    v_dot2c_f32_bf16 v32, v136, v28
    v_dot2c_f32_bf16 v33, v136, v29
    v_dot2c_f32_bf16 v34, v137, v28
    v_dot2c_f32_bf16 v35, v137, v29
    v_dot2c_f32_bf16 v36, v138, v28
    v_dot2c_f32_bf16 v37, v138, v29
    v_dot2c_f32_bf16 v38, v139, v28
    v_dot2c_f32_bf16 v39, v139, v29
    s_waitcnt vmcnt(6)
    s_cbranch_vccz L_aw147
    s_waitcnt vmcnt(4)
L_aw147:
    buffer_load_dwordx4 v[168:171], v1, s[40:43], s76 offen offset:256 nt
    v_dot2c_f32_bf16 v40, v140, v28
    v_dot2c_f32_bf16 v41, v140, v29
    v_dot2c_f32_bf16 v42, v141, v28
    v_dot2c_f32_bf16 v43, v141, v29
    v_dot2c_f32_bf16 v44, v142, v28
    v_dot2c_f32_bf16 v45, v142, v29
    v_dot2c_f32_bf16 v46, v143, v28
    v_dot2c_f32_bf16 v47, v143, v29
    s_waitcnt vmcnt(6)
    s_cbranch_vccz L_aw148
    s_waitcnt vmcnt(4)
L_aw148:
    s_add_u32 s80, s80, 3
    s_and_b32 s80, s80, 31
    s_mul_i32 s76, s80, 3072
    s_add_u32 s76, s76, 2064384
    buffer_load_dwordx4 v[172:175], v1, s[40:43], s76 offen offset:0 nt
    v_dot2c_f32_bf16 v48, v144, v28
    v_dot2c_f32_bf16 v49, v144, v29
    v_dot2c_f32_bf16 v50, v145, v28
    v_dot2c_f32_bf16 v51, v145, v29
    v_dot2c_f32_bf16 v52, v146, v28
    v_dot2c_f32_bf16 v53, v146, v29
    v_dot2c_f32_bf16 v54, v147, v28
    v_dot2c_f32_bf16 v55, v147, v29
    s_waitcnt vmcnt(6)
    s_cbranch_vccz L_aw149
    s_waitcnt vmcnt(4)
L_aw149:
    buffer_load_dwordx4 v[176:179], v1, s[40:43], s76 offen offset:128 nt
    v_mov_b32_dpp v30, v26 row_newbcast:3 row_mask:0xf bank_mask:0x3
    s_nop 1
    v_mov_b32_dpp v30, v26 row_newbcast:11 row_mask:0xf bank_mask:0xc
    v_lshlrev_b32 v31, 16, v30
    v_dot2c_f32_bf16 v32, v148, v30
    v_dot2c_f32_bf16 v33, v148, v31
    v_dot2c_f32_bf16 v34, v149, v30
    v_dot2c_f32_bf16 v35, v149, v31
    v_dot2c_f32_bf16 v36, v150, v30
    v_dot2c_f32_bf16 v37, v150, v31
    v_dot2c_f32_bf16 v38, v151, v30
    v_dot2c_f32_bf16 v39, v151, v31
    s_waitcnt vmcnt(6)
    s_cbranch_vccz L_aw150
    s_waitcnt vmcnt(4)
L_aw150:
    buffer_load_dwordx4 v[180:183], v1, s[40:43], s76 offen offset:256 nt
    v_dot2c_f32_bf16 v40, v152, v30
    v_dot2c_f32_bf16 v41, v152, v31
    v_dot2c_f32_bf16 v42, v153, v30
    v_dot2c_f32_bf16 v43, v153, v31
    v_dot2c_f32_bf16 v44, v154, v30
    v_dot2c_f32_bf16 v45, v154, v31
    v_dot2c_f32_bf16 v46, v155, v30
    v_dot2c_f32_bf16 v47, v155, v31
    s_waitcnt lgkmcnt(0)
    v_cmp_eq_u32 vcc, 0, v64
    v_add_u32 v65, 1, v65
    ds_write_b32 v57, v65 offset:11056
    ds_read_b32 v64, v58 offset:11015
    s_waitcnt vmcnt(6)
    s_cbranch_vccz L_aw151
    s_waitcnt vmcnt(4)
L_aw151:
    s_add_u32 s80, s80, 3
    s_and_b32 s80, s80, 31
    s_mul_i32 s76, s80, 3072
    s_add_u32 s76, s76, 2162688
    buffer_load_dwordx4 v[184:187], v1, s[40:43], s76 offen offset:0 nt
    v_dot2c_f32_bf16 v48, v156, v30
    v_dot2c_f32_bf16 v49, v156, v31
    v_dot2c_f32_bf16 v50, v157, v30
    v_dot2c_f32_bf16 v51, v157, v31
    v_dot2c_f32_bf16 v52, v158, v30
    v_dot2c_f32_bf16 v53, v158, v31
    v_dot2c_f32_bf16 v54, v159, v30
    v_dot2c_f32_bf16 v55, v159, v31
    s_waitcnt vmcnt(6)
    s_cbranch_vccz L_aw152
    s_waitcnt vmcnt(4)
L_aw152:
    buffer_load_dwordx4 v[188:191], v1, s[40:43], s76 offen offset:128 nt
    v_mov_b32_dpp v28, v26 row_newbcast:4 row_mask:0xf bank_mask:0x3
    s_nop 1
    v_mov_b32_dpp v28, v26 row_newbcast:12 row_mask:0xf bank_mask:0xc
    v_lshlrev_b32 v29, 16, v28
    v_dot2c_f32_bf16 v32, v160, v28
    v_dot2c_f32_bf16 v33, v160, v29
    v_dot2c_f32_bf16 v34, v161, v28
    v_dot2c_f32_bf16 v35, v161, v29
    v_dot2c_f32_bf16 v36, v162, v28
    v_dot2c_f32_bf16 v37, v162, v29
    v_dot2c_f32_bf16 v38, v163, v28
    v_dot2c_f32_bf16 v39, v163, v29
    s_waitcnt vmcnt(6)
    s_cbranch_vccz L_aw153
    s_waitcnt vmcnt(4)
L_aw153:
    buffer_load_dwordx4 v[192:195], v1, s[40:43], s76 offen offset:256 nt
    v_dot2c_f32_bf16 v40, v164, v28
    v_dot2c_f32_bf16 v41, v164, v29
    v_dot2c_f32_bf16 v42, v165, v28
    v_dot2c_f32_bf16 v43, v165, v29
    v_dot2c_f32_bf16 v44, v166, v28
    v_dot2c_f32_bf16 v45, v166, v29
    v_dot2c_f32_bf16 v46, v167, v28
    v_dot2c_f32_bf16 v47, v167, v29
    s_waitcnt vmcnt(6)
    s_cbranch_vccz L_aw154
    s_waitcnt vmcnt(4)
L_aw154:
    s_add_u32 s80, s80, 3
    s_and_b32 s80, s80, 31
    s_mul_i32 s76, s80, 3072
    s_add_u32 s76, s76, 2260992
    buffer_load_dwordx4 v[196:199], v1, s[40:43], s76 offen offset:0 nt
    v_dot2c_f32_bf16 v48, v168, v28
    v_dot2c_f32_bf16 v49, v168, v29
    v_dot2c_f32_bf16 v50, v169, v28
    v_dot2c_f32_bf16 v51, v169, v29
    v_dot2c_f32_bf16 v52, v170, v28
    v_dot2c_f32_bf16 v53, v170, v29
    v_dot2c_f32_bf16 v54, v171, v28
    v_dot2c_f32_bf16 v55, v171, v29
    s_waitcnt vmcnt(6)
    s_cbranch_vccz L_aw155
    s_waitcnt vmcnt(4)
L_aw155:
    buffer_load_dwordx4 v[200:203], v1, s[40:43], s76 offen offset:128 nt
    v_mov_b32_dpp v30, v26 row_newbcast:5 row_mask:0xf bank_mask:0x3
    s_nop 1
    v_mov_b32_dpp v30, v26 row_newbcast:13 row_mask:0xf bank_mask:0xc
    v_lshlrev_b32 v31, 16, v30
    v_dot2c_f32_bf16 v32, v172, v30
    v_dot2c_f32_bf16 v33, v172, v31
    v_dot2c_f32_bf16 v34, v173, v30
    v_dot2c_f32_bf16 v35, v173, v31
    v_dot2c_f32_bf16 v36, v174, v30
    v_dot2c_f32_bf16 v37, v174, v31
    v_dot2c_f32_bf16 v38, v175, v30
    v_dot2c_f32_bf16 v39, v175, v31
    s_waitcnt vmcnt(6)
    s_cbranch_vccz L_aw156
    s_waitcnt vmcnt(4)
L_aw156:
    buffer_load_dwordx4 v[204:207], v1, s[40:43], s76 offen offset:256 nt
    v_dot2c_f32_bf16 v40, v176, v30
    v_dot2c_f32_bf16 v41, v176, v31
    v_dot2c_f32_bf16 v42, v177, v30
    v_dot2c_f32_bf16 v43, v177, v31
    v_dot2c_f32_bf16 v44, v178, v30
    v_dot2c_f32_bf16 v45, v178, v31
    v_dot2c_f32_bf16 v46, v179, v30
    v_dot2c_f32_bf16 v47, v179, v31
    s_waitcnt lgkmcnt(0)
    v_cmp_eq_u32 vcc, 0, v64
    v_add_u32 v65, 1, v65
    ds_write_b32 v57, v65 offset:11056
    ds_read_b32 v64, v58 offset:11015
    s_waitcnt vmcnt(6)
    s_cbranch_vccz L_aw157
    s_waitcnt vmcnt(4)
L_aw157:
    s_add_u32 s80, s80, 3
    s_and_b32 s80, s80, 31
    s_mul_i32 s76, s80, 3072
    s_add_u32 s76, s76, 2359296
    buffer_load_dwordx4 v[208:211], v1, s[40:43], s76 offen offset:0 nt
    v_dot2c_f32_bf16 v48, v180, v30
    v_dot2c_f32_bf16 v49, v180, v31
    v_dot2c_f32_bf16 v50, v181, v30
    v_dot2c_f32_bf16 v51, v181, v31
    v_dot2c_f32_bf16 v52, v182, v30
    v_dot2c_f32_bf16 v53, v182, v31
    v_dot2c_f32_bf16 v54, v183, v30
    v_dot2c_f32_bf16 v55, v183, v31
    s_waitcnt vmcnt(6)
    s_cbranch_vccz L_aw158
    s_waitcnt vmcnt(4)
L_aw158:
    buffer_load_dwordx4 v[212:215], v1, s[40:43], s76 offen offset:128 nt
    v_mov_b32_dpp v28, v26 row_newbcast:6 row_mask:0xf bank_mask:0x3
    s_nop 1
    v_mov_b32_dpp v28, v26 row_newbcast:14 row_mask:0xf bank_mask:0xc
    v_lshlrev_b32 v29, 16, v28
    v_dot2c_f32_bf16 v32, v184, v28
    v_dot2c_f32_bf16 v33, v184, v29
    v_dot2c_f32_bf16 v34, v185, v28
    v_dot2c_f32_bf16 v35, v185, v29
    v_dot2c_f32_bf16 v36, v186, v28
    v_dot2c_f32_bf16 v37, v186, v29
    v_dot2c_f32_bf16 v38, v187, v28
    v_dot2c_f32_bf16 v39, v187, v29
    s_waitcnt vmcnt(11)
    buffer_load_dwordx4 v[216:219], v1, s[40:43], s76 offen offset:256 nt
    s_waitcnt vmcnt(11)
    s_add_u32 s80, s80, 3
    s_and_b32 s80, s80, 31
    s_mul_i32 s76, s80, 3072
    s_add_u32 s76, s76, 2457600
    buffer_load_dwordx4 v[220:223], v1, s[40:43], s76 offen offset:0 nt
    s_waitcnt vmcnt(11)
    buffer_load_dwordx4 v[224:227], v1, s[40:43], s76 offen offset:128 nt
    s_waitcnt vmcnt(11)
    buffer_load_dwordx4 v[228:231], v1, s[40:43], s76 offen offset:256 nt
    s_waitcnt lgkmcnt(0)
    v_cmp_eq_u32 vcc, 0, v64
    v_add_u32 v65, 1, v65
    ds_write_b32 v57, v65 offset:11056
    ds_read_b32 v64, v58 offset:11015
    s_waitcnt vmcnt(11)
    s_add_u32 s80, s80, 3
    s_and_b32 s80, s80, 31
    s_mul_i32 s76, s80, 3072
    s_add_u32 s76, s76, 2555904
    buffer_load_dwordx4 v[232:235], v1, s[40:43], s76 offen offset:0 nt
    s_waitcnt vmcnt(11)
    buffer_load_dwordx4 v[236:239], v1, s[40:43], s76 offen offset:128 nt
    v_dot2c_f32_bf16 v40, v188, v28
    v_dot2c_f32_bf16 v41, v188, v29
    v_dot2c_f32_bf16 v42, v189, v28
    v_dot2c_f32_bf16 v43, v189, v29
    v_dot2c_f32_bf16 v44, v190, v28
    v_dot2c_f32_bf16 v45, v190, v29
    v_dot2c_f32_bf16 v46, v191, v28
    v_dot2c_f32_bf16 v47, v191, v29
    s_waitcnt vmcnt(11)
    buffer_load_dwordx4 v[240:243], v1, s[40:43], s76 offen offset:256 nt
    v_dot2c_f32_bf16 v48, v192, v28
    v_dot2c_f32_bf16 v49, v192, v29
    v_dot2c_f32_bf16 v50, v193, v28
    v_dot2c_f32_bf16 v51, v193, v29
    v_dot2c_f32_bf16 v52, v194, v28
    v_dot2c_f32_bf16 v53, v194, v29
    v_dot2c_f32_bf16 v54, v195, v28
    v_dot2c_f32_bf16 v55, v195, v29
    s_waitcnt vmcnt(11)
    s_add_u32 s80, s80, 3
    s_and_b32 s80, s80, 31
    s_mul_i32 s76, s80, 3072
    s_add_u32 s76, s76, 2654208
    buffer_load_dwordx4 v[244:247], v1, s[40:43], s76 offen offset:0 nt
    v_mov_b32_dpp v30, v26 row_newbcast:7 row_mask:0xf bank_mask:0x3
    s_nop 1
    v_mov_b32_dpp v30, v26 row_newbcast:15 row_mask:0xf bank_mask:0xc
    v_lshlrev_b32 v31, 16, v30
    v_dot2c_f32_bf16 v32, v196, v30
    v_dot2c_f32_bf16 v33, v196, v31
    v_dot2c_f32_bf16 v34, v197, v30
    v_dot2c_f32_bf16 v35, v197, v31
    v_dot2c_f32_bf16 v36, v198, v30
    v_dot2c_f32_bf16 v37, v198, v31
    v_dot2c_f32_bf16 v38, v199, v30
    v_dot2c_f32_bf16 v39, v199, v31
    s_waitcnt vmcnt(11)
    buffer_load_dwordx4 v[248:251], v1, s[40:43], s76 offen offset:128 nt
    v_dot2c_f32_bf16 v40, v200, v30
    v_dot2c_f32_bf16 v41, v200, v31
    v_dot2c_f32_bf16 v42, v201, v30
    v_dot2c_f32_bf16 v43, v201, v31
    v_dot2c_f32_bf16 v44, v202, v30
    v_dot2c_f32_bf16 v45, v202, v31
    v_dot2c_f32_bf16 v46, v203, v30
    v_dot2c_f32_bf16 v47, v203, v31
    s_waitcnt vmcnt(11)
    buffer_load_dwordx4 v[252:255], v1, s[40:43], s76 offen offset:256 nt
    v_dot2c_f32_bf16 v48, v204, v30
    v_dot2c_f32_bf16 v49, v204, v31
    v_dot2c_f32_bf16 v50, v205, v30
    v_dot2c_f32_bf16 v51, v205, v31
    v_dot2c_f32_bf16 v52, v206, v30
    v_dot2c_f32_bf16 v53, v206, v31
    v_dot2c_f32_bf16 v54, v207, v30
    v_dot2c_f32_bf16 v55, v207, v31
    s_waitcnt lgkmcnt(0)
    v_cmp_eq_u32 vcc, 0, v64
    v_add_u32 v65, 1, v65
    ds_write_b32 v57, v65 offset:11056
    ds_read_b32 v64, v58 offset:11015
    s_waitcnt vmcnt(11)
    buffer_load_dwordx2 v[8:9], v59, s[44:47], 0 offen sc1
    s_add_u32 s80, s80, 3
    s_and_b32 s80, s80, 31
    s_mul_i32 s76, s80, 3072
    s_add_u32 s76, s76, 2752512
    buffer_load_dwordx4 v[76:79], v1, s[40:43], s76 offen offset:0 nt
    v_mov_b32_dpp v28, v27 row_newbcast:0 row_mask:0xf bank_mask:0x3
    s_nop 1
    v_mov_b32_dpp v28, v27 row_newbcast:8 row_mask:0xf bank_mask:0xc
    v_lshlrev_b32 v29, 16, v28
    v_dot2c_f32_bf16 v32, v208, v28
    v_dot2c_f32_bf16 v33, v208, v29
    v_dot2c_f32_bf16 v34, v209, v28
    v_dot2c_f32_bf16 v35, v209, v29
    v_dot2c_f32_bf16 v36, v210, v28
    v_dot2c_f32_bf16 v37, v210, v29
    v_dot2c_f32_bf16 v38, v211, v28
    v_dot2c_f32_bf16 v39, v211, v29
    s_waitcnt vmcnt(11)
    buffer_load_dwordx4 v[80:83], v1, s[40:43], s76 offen offset:128 nt
    v_dot2c_f32_bf16 v40, v212, v28
    v_dot2c_f32_bf16 v41, v212, v29
    v_dot2c_f32_bf16 v42, v213, v28
    v_dot2c_f32_bf16 v43, v213, v29
    v_dot2c_f32_bf16 v44, v214, v28
    v_dot2c_f32_bf16 v45, v214, v29
    v_dot2c_f32_bf16 v46, v215, v28
    v_dot2c_f32_bf16 v47, v215, v29
    v_dot2c_f32_bf16 v48, v216, v28
    v_dot2c_f32_bf16 v49, v216, v29
    v_dot2c_f32_bf16 v50, v217, v28
    v_dot2c_f32_bf16 v51, v217, v29
    v_dot2c_f32_bf16 v52, v218, v28
    v_dot2c_f32_bf16 v53, v218, v29
    v_dot2c_f32_bf16 v54, v219, v28
    v_dot2c_f32_bf16 v55, v219, v29
    s_waitcnt vmcnt(11)
    buffer_load_dwordx4 v[84:87], v1, s[40:43], s76 offen offset:256 nt
    v_mov_b32_dpp v30, v27 row_newbcast:1 row_mask:0xf bank_mask:0x3
    s_nop 1
    v_mov_b32_dpp v30, v27 row_newbcast:9 row_mask:0xf bank_mask:0xc
    v_lshlrev_b32 v31, 16, v30
    v_dot2c_f32_bf16 v32, v220, v30
    v_dot2c_f32_bf16 v33, v220, v31
    v_dot2c_f32_bf16 v34, v221, v30
    v_dot2c_f32_bf16 v35, v221, v31
    v_dot2c_f32_bf16 v36, v222, v30
    v_dot2c_f32_bf16 v37, v222, v31
    v_dot2c_f32_bf16 v38, v223, v30
    v_dot2c_f32_bf16 v39, v223, v31
    s_waitcnt vmcnt(11)
    s_add_u32 s80, s80, 3
    s_and_b32 s80, s80, 31
    s_mul_i32 s76, s80, 3072
    s_add_u32 s76, s76, 2850816
    buffer_load_dwordx4 v[88:91], v1, s[40:43], s76 offen offset:0 nt
    v_dot2c_f32_bf16 v40, v224, v30
    v_dot2c_f32_bf16 v41, v224, v31
    v_dot2c_f32_bf16 v42, v225, v30
    v_dot2c_f32_bf16 v43, v225, v31
    v_dot2c_f32_bf16 v44, v226, v30
    v_dot2c_f32_bf16 v45, v226, v31
    v_dot2c_f32_bf16 v46, v227, v30
    v_dot2c_f32_bf16 v47, v227, v31
    s_waitcnt vmcnt(11)
    buffer_load_dwordx4 v[92:95], v1, s[40:43], s76 offen offset:128 nt
    v_dot2c_f32_bf16 v48, v228, v30
    v_dot2c_f32_bf16 v49, v228, v31
    v_dot2c_f32_bf16 v50, v229, v30
    v_dot2c_f32_bf16 v51, v229, v31
    v_dot2c_f32_bf16 v52, v230, v30
    v_dot2c_f32_bf16 v53, v230, v31
    v_dot2c_f32_bf16 v54, v231, v30
    v_dot2c_f32_bf16 v55, v231, v31
    s_waitcnt vmcnt(11)
    buffer_load_dwordx4 v[96:99], v1, s[40:43], s76 offen offset:256 nt
    v_mov_b32_dpp v28, v27 row_newbcast:2 row_mask:0xf bank_mask:0x3
    s_nop 1
    v_mov_b32_dpp v28, v27 row_newbcast:10 row_mask:0xf bank_mask:0xc
    v_lshlrev_b32 v29, 16, v28
    v_dot2c_f32_bf16 v32, v232, v28
    v_dot2c_f32_bf16 v33, v232, v29
    v_dot2c_f32_bf16 v34, v233, v28
    v_dot2c_f32_bf16 v35, v233, v29
    v_dot2c_f32_bf16 v36, v234, v28
    v_dot2c_f32_bf16 v37, v234, v29
    v_dot2c_f32_bf16 v38, v235, v28
    v_dot2c_f32_bf16 v39, v235, v29
    s_waitcnt lgkmcnt(0)
    v_cmp_eq_u32 vcc, 0, v64
    v_add_u32 v65, 1, v65
    ds_write_b32 v57, v65 offset:11056
    ds_read_b32 v64, v58 offset:11015
    s_waitcnt vmcnt(11)
    s_add_u32 s80, s80, 3
    s_and_b32 s80, s80, 31
    s_mul_i32 s76, s80, 3072
    s_add_u32 s76, s76, 2949120
    buffer_load_dwordx4 v[100:103], v1, s[40:43], s76 offen offset:0 nt
    v_dot2c_f32_bf16 v40, v236, v28
    v_dot2c_f32_bf16 v41, v236, v29
    v_dot2c_f32_bf16 v42, v237, v28
    v_dot2c_f32_bf16 v43, v237, v29
    v_dot2c_f32_bf16 v44, v238, v28
    v_dot2c_f32_bf16 v45, v238, v29
    v_dot2c_f32_bf16 v46, v239, v28
    v_dot2c_f32_bf16 v47, v239, v29
    s_waitcnt vmcnt(11)
    buffer_load_dwordx4 v[104:107], v1, s[40:43], s76 offen offset:128 nt
    v_dot2c_f32_bf16 v48, v240, v28
    v_dot2c_f32_bf16 v49, v240, v29
    v_dot2c_f32_bf16 v50, v241, v28
    v_dot2c_f32_bf16 v51, v241, v29
    v_dot2c_f32_bf16 v52, v242, v28
    v_dot2c_f32_bf16 v53, v242, v29
    v_dot2c_f32_bf16 v54, v243, v28
    v_dot2c_f32_bf16 v55, v243, v29
    s_waitcnt vmcnt(11)
    buffer_load_dwordx4 v[108:111], v1, s[40:43], s76 offen offset:256 nt
    v_mov_b32_dpp v30, v27 row_newbcast:3 row_mask:0xf bank_mask:0x3
    s_nop 1
    v_mov_b32_dpp v30, v27 row_newbcast:11 row_mask:0xf bank_mask:0xc
    v_lshlrev_b32 v31, 16, v30
    v_dot2c_f32_bf16 v32, v244, v30
    v_dot2c_f32_bf16 v33, v244, v31
    v_dot2c_f32_bf16 v34, v245, v30
    v_dot2c_f32_bf16 v35, v245, v31
    v_dot2c_f32_bf16 v36, v246, v30
    v_dot2c_f32_bf16 v37, v246, v31
    v_dot2c_f32_bf16 v38, v247, v30
    v_dot2c_f32_bf16 v39, v247, v31
    s_waitcnt vmcnt(11)
    s_add_u32 s80, s80, 3
    s_and_b32 s80, s80, 31
    s_mul_i32 s76, s80, 3072
    s_add_u32 s76, s76, 3047424
    buffer_load_dwordx4 v[112:115], v1, s[40:43], s76 offen offset:0 nt
    ds_write_b32 v57, v58 offset:11040
    v_dot2c_f32_bf16 v40, v248, v30
    v_dot2c_f32_bf16 v41, v248, v31
    v_dot2c_f32_bf16 v42, v249, v30
    v_dot2c_f32_bf16 v43, v249, v31
    v_dot2c_f32_bf16 v44, v250, v30
    v_dot2c_f32_bf16 v45, v250, v31
    v_dot2c_f32_bf16 v46, v251, v30
    v_dot2c_f32_bf16 v47, v251, v31
    s_waitcnt vmcnt(11)
    buffer_load_dwordx4 v[116:119], v1, s[40:43], s76 offen offset:128 nt
    v_dot2c_f32_bf16 v48, v252, v30
    v_dot2c_f32_bf16 v49, v252, v31
    v_dot2c_f32_bf16 v50, v253, v30
    v_dot2c_f32_bf16 v51, v253, v31
    v_dot2c_f32_bf16 v52, v254, v30
    v_dot2c_f32_bf16 v53, v254, v31
    v_dot2c_f32_bf16 v54, v255, v30
    v_dot2c_f32_bf16 v55, v255, v31
    s_waitcnt vmcnt(11)
    buffer_load_dwordx4 v[120:123], v1, s[40:43], s76 offen offset:256 nt
    s_branch L_mlcalc
L_mlretry:
    s_nop 4
    s_sub_u32 s75, s75, 1
    s_cbranch_scc1 L_end
    s_sleep 8
    buffer_load_dwordx2 v[8:9], v59, s[44:47], 0 offen sc1
    s_waitcnt vmcnt(0)
L_mlcalc:
    s_nop 4
    v_max_u32 v2, v8, v9
    v_cmp_eq_u32 vcc, -1, v2
    s_cbranch_vccnz L_mlretry
    v_mov_b32 v3, v8
    v_mov_b32 v2, v3
    s_nop 1
    v_permlane16_swap_b32 v3, v2
    v_max_f32 v3, v3, v2
    s_nop 1
    v_max_f32_dpp v3, v3, v3 row_ror:8 row_mask:0xf bank_mask:0xf
    s_nop 1
    v_max_f32_dpp v3, v3, v3 row_ror:4 row_mask:0xf bank_mask:0xf
    s_nop 1
    v_max_f32_dpp v3, v3, v3 row_ror:2 row_mask:0xf bank_mask:0xf
    s_nop 1
    v_max_f32_dpp v3, v3, v3 row_ror:1 row_mask:0xf bank_mask:0xf
    v_sub_f32 v8, v8, v3
    v_sub_f32 v60, v60, v3
    v_mul_f32 v8, 0x3fb8aa3b, v8
    v_mul_f32 v60, 0x3fb8aa3b, v60
    v_exp_f32 v8, v8
    v_exp_f32 v60, v60
    v_mul_f32 v8, v8, v9
    v_mov_b32 v2, v8
    s_nop 1
    v_permlane16_swap_b32 v8, v2
    v_add_f32 v8, v8, v2
    s_nop 1
    v_add_f32_dpp v8, v8, v8 row_ror:8 row_mask:0xf bank_mask:0xf
    s_nop 1
    v_add_f32_dpp v8, v8, v8 row_ror:4 row_mask:0xf bank_mask:0xf
    s_nop 1
    v_add_f32_dpp v8, v8, v8 row_ror:2 row_mask:0xf bank_mask:0xf
    s_nop 1
    v_add_f32_dpp v8, v8, v8 row_ror:1 row_mask:0xf bank_mask:0xf
    v_rcp_f32 v8, v8
    s_nop 0
    v_mul_f32 v60, v60, v8
    v_mov_b32_dpp v28, v27 row_newbcast:4 row_mask:0xf bank_mask:0x3
    s_nop 1
    v_mov_b32_dpp v28, v27 row_newbcast:12 row_mask:0xf bank_mask:0xc
    v_lshlrev_b32 v29, 16, v28
    s_waitcnt vmcnt(11)
    v_dot2c_f32_bf16 v32, v76, v28
    v_dot2c_f32_bf16 v33, v76, v29
    v_dot2c_f32_bf16 v34, v77, v28
    v_dot2c_f32_bf16 v35, v77, v29
    v_dot2c_f32_bf16 v36, v78, v28
    v_dot2c_f32_bf16 v37, v78, v29
    v_dot2c_f32_bf16 v38, v79, v28
    v_dot2c_f32_bf16 v39, v79, v29
    s_waitcnt vmcnt(10)
    v_dot2c_f32_bf16 v40, v80, v28
    v_dot2c_f32_bf16 v41, v80, v29
    v_dot2c_f32_bf16 v42, v81, v28
    v_dot2c_f32_bf16 v43, v81, v29
    v_dot2c_f32_bf16 v44, v82, v28
    v_dot2c_f32_bf16 v45, v82, v29
    v_dot2c_f32_bf16 v46, v83, v28
    v_dot2c_f32_bf16 v47, v83, v29
    s_waitcnt vmcnt(9)
    v_dot2c_f32_bf16 v48, v84, v28
    v_dot2c_f32_bf16 v49, v84, v29
    v_dot2c_f32_bf16 v50, v85, v28
    v_dot2c_f32_bf16 v51, v85, v29
    v_dot2c_f32_bf16 v52, v86, v28
    v_dot2c_f32_bf16 v53, v86, v29
    v_dot2c_f32_bf16 v54, v87, v28
    v_dot2c_f32_bf16 v55, v87, v29
    v_mov_b32_dpp v30, v27 row_newbcast:5 row_mask:0xf bank_mask:0x3
    s_nop 1
    v_mov_b32_dpp v30, v27 row_newbcast:13 row_mask:0xf bank_mask:0xc
    v_lshlrev_b32 v31, 16, v30
    s_waitcnt vmcnt(8)
    v_dot2c_f32_bf16 v32, v88, v30
    v_dot2c_f32_bf16 v33, v88, v31
    v_dot2c_f32_bf16 v34, v89, v30
    v_dot2c_f32_bf16 v35, v89, v31
    v_dot2c_f32_bf16 v36, v90, v30
    v_dot2c_f32_bf16 v37, v90, v31
    v_dot2c_f32_bf16 v38, v91, v30
    v_dot2c_f32_bf16 v39, v91, v31
    s_waitcnt vmcnt(7)
    v_dot2c_f32_bf16 v40, v92, v30
    v_dot2c_f32_bf16 v41, v92, v31
    v_dot2c_f32_bf16 v42, v93, v30
    v_dot2c_f32_bf16 v43, v93, v31
    v_dot2c_f32_bf16 v44, v94, v30
    v_dot2c_f32_bf16 v45, v94, v31
    v_dot2c_f32_bf16 v46, v95, v30
    v_dot2c_f32_bf16 v47, v95, v31
    s_waitcnt vmcnt(6)
    v_dot2c_f32_bf16 v48, v96, v30
    v_dot2c_f32_bf16 v49, v96, v31
    v_dot2c_f32_bf16 v50, v97, v30
    v_dot2c_f32_bf16 v51, v97, v31
    v_dot2c_f32_bf16 v52, v98, v30
    v_dot2c_f32_bf16 v53, v98, v31
    v_dot2c_f32_bf16 v54, v99, v30
    v_dot2c_f32_bf16 v55, v99, v31
    v_mov_b32_dpp v28, v27 row_newbcast:6 row_mask:0xf bank_mask:0x3
    s_nop 1
    v_mov_b32_dpp v28, v27 row_newbcast:14 row_mask:0xf bank_mask:0xc
    v_lshlrev_b32 v29, 16, v28
    s_waitcnt vmcnt(5)
    v_dot2c_f32_bf16 v32, v100, v28
    v_dot2c_f32_bf16 v33, v100, v29
    v_dot2c_f32_bf16 v34, v101, v28
    v_dot2c_f32_bf16 v35, v101, v29
    v_dot2c_f32_bf16 v36, v102, v28
    v_dot2c_f32_bf16 v37, v102, v29
    v_dot2c_f32_bf16 v38, v103, v28
    v_dot2c_f32_bf16 v39, v103, v29
    s_waitcnt vmcnt(4)
    v_dot2c_f32_bf16 v40, v104, v28
    v_dot2c_f32_bf16 v41, v104, v29
    v_dot2c_f32_bf16 v42, v105, v28
    v_dot2c_f32_bf16 v43, v105, v29
    v_dot2c_f32_bf16 v44, v106, v28
    v_dot2c_f32_bf16 v45, v106, v29
    v_dot2c_f32_bf16 v46, v107, v28
    v_dot2c_f32_bf16 v47, v107, v29
    s_waitcnt vmcnt(3)
    v_dot2c_f32_bf16 v48, v108, v28
    v_dot2c_f32_bf16 v49, v108, v29
    v_dot2c_f32_bf16 v50, v109, v28
    v_dot2c_f32_bf16 v51, v109, v29
    v_dot2c_f32_bf16 v52, v110, v28
    v_dot2c_f32_bf16 v53, v110, v29
    v_dot2c_f32_bf16 v54, v111, v28
    v_dot2c_f32_bf16 v55, v111, v29
    v_mov_b32_dpp v30, v27 row_newbcast:7 row_mask:0xf bank_mask:0x3
    s_nop 1
    v_mov_b32_dpp v30, v27 row_newbcast:15 row_mask:0xf bank_mask:0xc
    v_lshlrev_b32 v31, 16, v30
    s_waitcnt vmcnt(2)
    v_dot2c_f32_bf16 v32, v112, v30
    v_dot2c_f32_bf16 v33, v112, v31
    v_dot2c_f32_bf16 v34, v113, v30
    v_dot2c_f32_bf16 v35, v113, v31
    v_dot2c_f32_bf16 v36, v114, v30
    v_dot2c_f32_bf16 v37, v114, v31
    v_dot2c_f32_bf16 v38, v115, v30
    v_dot2c_f32_bf16 v39, v115, v31
    s_waitcnt vmcnt(1)
    v_dot2c_f32_bf16 v40, v116, v30
    v_dot2c_f32_bf16 v41, v116, v31
    v_dot2c_f32_bf16 v42, v117, v30
    v_dot2c_f32_bf16 v43, v117, v31
    v_dot2c_f32_bf16 v44, v118, v30
    v_dot2c_f32_bf16 v45, v118, v31
    v_dot2c_f32_bf16 v46, v119, v30
    v_dot2c_f32_bf16 v47, v119, v31
    s_waitcnt vmcnt(0)
    v_dot2c_f32_bf16 v48, v120, v30
    v_dot2c_f32_bf16 v49, v120, v31
    v_dot2c_f32_bf16 v50, v121, v30
    v_dot2c_f32_bf16 v51, v121, v31
    v_dot2c_f32_bf16 v52, v122, v30
    v_dot2c_f32_bf16 v53, v122, v31
    v_dot2c_f32_bf16 v54, v123, v30
    v_dot2c_f32_bf16 v55, v123, v31
    v_permlane32_swap_b32 v32, v44
    v_permlane32_swap_b32 v33, v45
    v_permlane32_swap_b32 v34, v46
    v_permlane32_swap_b32 v35, v47
    v_permlane32_swap_b32 v36, v48
    v_permlane32_swap_b32 v37, v49
    v_permlane32_swap_b32 v38, v50
    v_permlane32_swap_b32 v39, v51
    v_permlane32_swap_b32 v40, v52
    v_permlane32_swap_b32 v41, v53
    v_permlane32_swap_b32 v42, v54
    v_permlane32_swap_b32 v43, v55
    v_add_f32 v32, v32, v44
    v_add_f32 v33, v33, v45
    v_add_f32 v34, v34, v46
    v_add_f32 v35, v35, v47
    v_add_f32 v36, v36, v48
    v_add_f32 v37, v37, v49
    v_add_f32 v38, v38, v50
    v_add_f32 v39, v39, v51
    v_add_f32 v40, v40, v52
    v_add_f32 v41, v41, v53
    v_add_f32 v42, v42, v54
    v_add_f32 v43, v43, v55
    v_permlane16_swap_b32 v32, v38
    v_permlane16_swap_b32 v33, v39
    v_permlane16_swap_b32 v34, v40
    v_permlane16_swap_b32 v35, v41
    v_permlane16_swap_b32 v36, v42
    v_permlane16_swap_b32 v37, v43
    v_add_f32 v32, v32, v38
    v_add_f32 v33, v33, v39
    v_add_f32 v34, v34, v40
    v_add_f32 v35, v35, v41
    v_add_f32 v36, v36, v42
    v_add_f32 v37, v37, v43
    v_add_f32_dpp v32, v32, v32 row_ror:8 row_mask:0xf bank_mask:0x3
    v_add_f32_dpp v33, v33, v33 row_ror:8 row_mask:0xf bank_mask:0x3
    v_add_f32_dpp v34, v34, v34 row_ror:8 row_mask:0xf bank_mask:0x3
    v_add_f32_dpp v32, v35, v35 row_ror:8 row_mask:0xf bank_mask:0xc
    v_add_f32_dpp v33, v36, v36 row_ror:8 row_mask:0xf bank_mask:0xc
    v_add_f32_dpp v34, v37, v37 row_ror:8 row_mask:0xf bank_mask:0xc
    v_mul_f32 v32, v32, v60
    v_mul_f32 v33, v33, v60
    v_mul_f32 v34, v34, v60
    ds_write_b96 v4, v[32:34] offset:2816
    s_mov_b64 exec, 1
    ds_add_rtn_u32 v2, v5, v58 offset:11008
    s_mov_b64 exec, -1
    ds_read_b96 v[32:34], v6 offset:2816
    ds_read_b96 v[36:38], v6 offset:3840
    ds_read_b96 v[40:42], v6 offset:4864
    ds_read_b96 v[44:46], v6 offset:5888
    s_waitcnt lgkmcnt(4)
    v_readfirstlane_b32 s35, v2
    s_nop 0
    s_cmp_eq_u32 s35, 3
    s_cbranch_scc0 L_notlast
    s_waitcnt lgkmcnt(2)
    v_add_f32 v32, v32, v36
    v_add_f32 v33, v33, v37
    v_add_f32 v34, v34, v38
    s_waitcnt lgkmcnt(0)
    v_add_f32 v40, v40, v44
    v_add_f32 v41, v41, v45
    v_add_f32 v42, v42, v46
    v_add_f32 v32, v32, v40
    buffer_store_dword v32, v7, s[44:47], s14 offen sc1
    v_add_f32 v33, v33, v41
    buffer_store_dword v33, v7, s[44:47], s14 offen offset:2048 sc1
    v_add_f32 v34, v34, v42
    buffer_store_dword v34, v7, s[44:47], s15 offen sc1
L_notlast:
    s_nop 4
    s_waitcnt lgkmcnt(0)
    s_cmp_eq_u32 s6, 1
    s_cbranch_scc1 L_fin
    v_mov_b32 v8, v7
    s_lshl_b32 s34, s5, 2
    s_add_u32 s34, s34, s7
    s_mul_i32 s19, s34, 26
    s_lshr_b32 s19, s19, 8
    s_mul_i32 s18, s19, 10
    s_sub_u32 s18, s34, s18
    s_cmp_lt_u32 s34, 30
    s_cselect_b32 s20, 1, 0
    s_cmp_lt_u32 s2, 80
    s_cselect_b32 s21, 1, 0
    s_cmp_eq_u32 s7, 3
    s_cselect_b32 s21, s21, 0
    s_or_b32 s34, s20, s21
    s_cmp_eq_u32 s34, 0
    s_cbranch_scc1 L_fin
    v_mul_u32_u24 v3, 3, v62
    v_add_u32 v3, s19, v3
    v_lshrrev_b32 v4, 3, v3
    v_and_b32 v3, 7, v3
    v_lshl_add_u32 v3, v4, 6, v3
    v_mul_u32_u24 v3, 1280, v3
    v_lshl_add_u32 v3, v63, 4, v3
    v_lshlrev_b32 v9, 2, v62
    v_lshl_add_u32 v9, v63, 5, v9
    s_mul_i32 s34, s4, 245760
    s_lshl_b32 s35, s18, 7
    s_add_u32 s34, s34, s35
    s_mul_i32 s16, s4, 12288
    s_lshl_b32 s35, s19, 11
    s_add_u32 s16, s16, s35
    s_add_u32 s16, s16, 393216
    s_mul_i32 s22, s18, 24576
    s_mul_i32 s35, s4, 768
    s_add_u32 s22, s22, s35
    s_lshl_b32 s35, s19, 8
    s_add_u32 s22, s22, s35
    s_add_u32 s22, s22, 1048576
    s_mov_b32 s17, 0
    s_mov_b32 s74, s34
    v_mov_b32 v29, v3
    s_mov_b32 s77, 0
    s_cmp_eq_u32 s20, 0
    s_cbranch_scc1 L_rinit
    buffer_load_dwordx4 v[64:67], v29, s[52:55], s74 offen nt
    s_add_u32 s74, s74, 10240
    buffer_load_dwordx4 v[68:71], v29, s[52:55], s74 offen nt
    s_add_u32 s74, s74, 10240
    s_waitcnt vmcnt(1)
    buffer_load_dwordx4 v[72:75], v29, s[52:55], s74 offen nt
    s_add_u32 s74, s74, 10240
    s_waitcnt vmcnt(1)
    buffer_load_dwordx4 v[76:79], v29, s[52:55], s74 offen nt
    s_add_u32 s74, s74, 10240
    s_waitcnt vmcnt(1)
    buffer_load_dwordx4 v[80:83], v29, s[52:55], s74 offen nt
    s_add_u32 s74, s74, 10240
    s_waitcnt vmcnt(1)
    buffer_load_dwordx4 v[84:87], v29, s[52:55], s74 offen nt
    s_add_u32 s74, s74, 10240
    s_waitcnt vmcnt(1)
    buffer_load_dwordx4 v[88:91], v29, s[52:55], s74 offen nt
    s_add_u32 s74, s74, 10240
    s_waitcnt vmcnt(1)
    buffer_load_dwordx4 v[92:95], v29, s[52:55], s74 offen nt
    s_add_u32 s74, s74, 10240
    s_waitcnt vmcnt(0)
    v_perm_b32 v96, v68, v64, s82
    v_perm_b32 v97, v68, v64, s83
    v_perm_b32 v98, v69, v65, s82
    v_perm_b32 v99, v69, v65, s83
    v_perm_b32 v100, v70, v66, s82
    v_perm_b32 v101, v70, v66, s83
    v_perm_b32 v102, v71, v67, s82
    v_perm_b32 v103, v71, v67, s83
    v_perm_b32 v104, v76, v72, s82
    v_perm_b32 v105, v76, v72, s83
    v_perm_b32 v106, v77, v73, s82
    v_perm_b32 v107, v77, v73, s83
    v_perm_b32 v108, v78, v74, s82
    v_perm_b32 v109, v78, v74, s83
    v_perm_b32 v110, v79, v75, s82
    v_perm_b32 v111, v79, v75, s83
    v_perm_b32 v112, v84, v80, s82
    v_perm_b32 v113, v84, v80, s83
    v_perm_b32 v114, v85, v81, s82
    v_perm_b32 v115, v85, v81, s83
    v_perm_b32 v116, v86, v82, s82
    v_perm_b32 v117, v86, v82, s83
    v_perm_b32 v118, v87, v83, s82
    v_perm_b32 v119, v87, v83, s83
    v_perm_b32 v120, v92, v88, s82
    v_perm_b32 v121, v92, v88, s83
    v_perm_b32 v122, v93, v89, s82
    v_perm_b32 v123, v93, v89, s83
    v_perm_b32 v124, v94, v90, s82
    v_perm_b32 v125, v94, v90, s83
    v_perm_b32 v126, v95, v91, s82
    v_perm_b32 v127, v95, v91, s83
L_rinit:
    s_nop 4
    v_mov_b32 v2, 11032
    ds_read_b32 v3, v2
    s_mul_i32 s34, s5, 4
    s_sub_u32 s34, s4, s34
    s_and_b32 s34, s34, 31
    s_lshl_b32 s34, s34, 10
    s_add_u32 s34, s34, 294912
    s_add_u32 s8, s32, s34
    s_addc_u32 s9, s33, 0
    s_lshl_b32 s35, s5, 7
    s_add_u32 s34, s34, s35
    v_lshl_add_u32 v61, v0, 3, s34
    v_mov_b32 v2, 1073741824
    v_cmp_gt_u32 vcc, 16, v0
    s_nop 1
    v_cndmask_b32 v61, v2, v61, vcc
    s_mov_b32 s73, 168
    s_mov_b32 s12, 0
    s_waitcnt lgkmcnt(0)
    v_readfirstlane_b32 s13, v3
    s_cmp_eq_u32 s21, 0
    s_cbranch_scc1 L_oloop
    s_cmp_ge_u32 s2, 40
    s_cselect_b32 s23, 1, 0
    s_mul_i32 s24, s23, 40
    s_sub_u32 s24, s2, s24
    s_mul_i32 s34, s23, 1280
    v_mul_u32_u24 v2, 20, v0
    buffer_load_dwordx4 v[22:25], v2, s[60:63], 0 offen
    buffer_load_dword v26, v2, s[60:63], 0 offen offset:16
    v_add_u32 v2, s34, v2
    ds_read_b32 v16, v2 offset:11072
    ds_read_b32 v17, v2 offset:11076
    ds_read_b32 v18, v2 offset:11080
    ds_read_b32 v19, v2 offset:11084
    ds_read_b32 v20, v2 offset:11088
    v_and_b32 v3, 3, v0
    v_lshlrev_b32 v3, 2, v3
    v_lshrrev_b32 v4, 4, v0
    v_add_u32 v3, v3, v4
    s_lshl_b32 s35, s24, 4
    v_add_u32 v3, s35, v3
    v_lshl_add_u32 v10, v3, 1, s34
    buffer_load_ushort v11, v10, s[48:51], 0 offen
    ds_read_u16 v12, v10 offset:11072
    v_mov_b32 v2, 11032
    ds_read_b64 v[6:7], v2
    v_lshlrev_b32 v2, 7, v0
    s_mov_b32 s34, 262144
    s_mov_b32 s35, 270336
    s_mov_b32 s25, 278528
    s_mov_b32 s26, 286720
L_fpoll:
    s_nop 4
    s_sub_u32 s75, s75, 1
    s_cbranch_scc1 L_end
    buffer_load_dwordx2 v[32:33], v2, s[44:47], s34 offen sc1
    buffer_load_dwordx2 v[34:35], v2, s[44:47], s35 offen sc1
    buffer_load_dwordx2 v[36:37], v2, s[44:47], s25 offen sc1
    buffer_load_dwordx2 v[38:39], v2, s[44:47], s26 offen sc1
    s_waitcnt vmcnt(0) lgkmcnt(0)
    v_cmp_ne_u64 vcc, v[32:33], v[6:7]
    v_cmp_ne_u64 s[68:69], v[34:35], v[6:7]
    s_nop 0
    s_or_b64 vcc, vcc, s[68:69]
    v_cmp_ne_u64 s[68:69], v[36:37], v[6:7]
    s_nop 0
    s_or_b64 vcc, vcc, s[68:69]
    v_cmp_ne_u64 s[68:69], v[38:39], v[6:7]
    s_nop 0
    s_or_b64 vcc, vcc, s[68:69]
    s_cbranch_scc1 L_fpoll
    v_mov_b32 v13, 0
    v_dot2c_f32_bf16 v13, v16, v22
    v_dot2c_f32_bf16 v13, v17, v23
    v_dot2c_f32_bf16 v13, v18, v24
    v_dot2c_f32_bf16 v13, v19, v25
    v_dot2c_f32_bf16 v13, v20, v26
    s_nop 2
    v_mov_b32 v2, v13
    s_nop 1
    v_permlane32_swap_b32 v13, v2
    v_add_f32 v13, v13, v2
    v_mov_b32 v2, v13
    s_nop 1
    v_permlane16_swap_b32 v13, v2
    v_add_f32 v13, v13, v2
    s_nop 1
    v_add_f32_dpp v13, v13, v13 row_ror:8 row_mask:0xf bank_mask:0xf
    s_nop 1
    v_add_f32_dpp v13, v13, v13 row_ror:4 row_mask:0xf bank_mask:0xf
    s_nop 1
    v_add_f32_dpp v13, v13, v13 row_ror:2 row_mask:0xf bank_mask:0xf
    s_nop 1
    v_add_f32_dpp v13, v13, v13 row_ror:1 row_mask:0xf bank_mask:0xf
    v_cvt_pk_bf16_f32 v13, v13, v13
    v_and_b32 v13, 0xffff0000, v13
    v_mul_f32 v13, 0xbfb8aa3b, v13
    v_exp_f32 v13, v13
    s_nop 0
    v_add_f32 v13, 1.0, v13
    v_rcp_f32 v13, v13
    s_nop 0
    v_cvt_pk_bf16_f32 v13, v13, v13
    v_and_b32 v13, 0xffff0000, v13
    v_lshlrev_b32 v11, 16, v11
    v_lshlrev_b32 v12, 16, v12
    v_lshrrev_b32 v2, 2, v0
    v_lshlrev_b32 v2, 8, v2
    v_and_b32 v3, 3, v0
    v_lshl_add_u32 v14, v3, 4, v2
    s_and_b32 s34, s24, 3
    s_lshl_b32 s34, s34, 6
    v_add_u32 v14, s34, v14
    s_lshr_b32 s34, s24, 2
    s_mul_i32 s35, s23, 10
    s_add_u32 s34, s34, s35
    s_mul_i32 s25, s34, 6144
    s_add_u32 s25, s25, 1572864
    s_add_u32 s26, s25, 4096
    v_mov_b32 v15, 1073741824
    v_cmp_gt_u32 vcc, 32, v0
    s_nop 1
    v_cndmask_b32 v30, v15, v14, vcc
    s_mul_i32 s71, s34, 24576
    s_add_u32 s71, s71, 1048576
    s_add_u32 s27, s71, 8192
    s_add_u32 s68, s71, 12288
    s_add_u32 s69, s71, 16384
    s_add_u32 s70, s71, 20480
L_oloop:
    s_nop 4
    s_lshl_b32 s34, s17, 2
    v_mov_b32 v31, s34
L_cwait:
    s_nop 4
    s_sub_u32 s75, s75, 1
    s_cbranch_scc1 L_end
    ds_read_b32 v4, v31 offset:11008
    s_waitcnt lgkmcnt(0)
    v_readfirstlane_b32 s34, v4
    s_nop 0
    s_cmp_eq_u32 s34, 4
    s_cbranch_scc1 L_go
    s_or_b32 s34, s34, s3
    s_cmp_eq_u32 s34, 0
    s_cbranch_scc0 L_cw2
    v_mov_b32 v2, 0
    ds_read_b128 v[4:7], v2 offset:11056
    s_waitcnt lgkmcnt(0)
    v_add_u32 v4, v4, v5
    v_add3_u32 v4, v4, v6, v7
    s_nop 0
    v_readfirstlane_b32 s35, v4
    s_nop 0
    s_cmp_lt_u32 s35, s73
    s_cbranch_scc1 L_cs2
    s_memrealtime s[80:81]
    s_load_dwordx2 s[36:37], s[8:9], 0 glc
    s_load_dwordx2 s[38:39], s[8:9], 128 glc
    s_load_dwordx2 s[40:41], s[8:9], 256 glc
    s_load_dwordx2 s[42:43], s[8:9], 384 glc
    s_load_dwordx2 s[56:57], s[8:9], 512 glc
    s_load_dwordx2 s[58:59], s[8:9], 640 glc
    s_load_dwordx2 s[10:11], s[8:9], 768 glc
    s_load_dwordx2 s[14:15], s[8:9], 896 glc
    s_xor_b32 s12, s73, s13
    v_mov_b32 v4, s12
    s_waitcnt lgkmcnt(0)
    v_mov_b32 v5, s80
    buffer_store_dwordx2 v[4:5], v61, s[44:47], 0 offen sc1
    s_mov_b32 s34, 0
    s_sub_u32 s37, s80, s37
    s_max_i32 s37, s37, 0
    s_cmp_eq_u32 s36, s12
    s_cselect_b32 s37, s37, 0
    s_add_u32 s34, s34, s37
    s_sub_u32 s39, s80, s39
    s_max_i32 s39, s39, 0
    s_cmp_eq_u32 s38, s12
    s_cselect_b32 s39, s39, 0
    s_add_u32 s34, s34, s39
    s_sub_u32 s41, s80, s41
    s_max_i32 s41, s41, 0
    s_cmp_eq_u32 s40, s12
    s_cselect_b32 s41, s41, 0
    s_add_u32 s34, s34, s41
    s_sub_u32 s43, s80, s43
    s_max_i32 s43, s43, 0
    s_cmp_eq_u32 s42, s12
    s_cselect_b32 s43, s43, 0
    s_add_u32 s34, s34, s43
    s_sub_u32 s57, s80, s57
    s_max_i32 s57, s57, 0
    s_cmp_eq_u32 s56, s12
    s_cselect_b32 s57, s57, 0
    s_add_u32 s34, s34, s57
    s_sub_u32 s59, s80, s59
    s_max_i32 s59, s59, 0
    s_cmp_eq_u32 s58, s12
    s_cselect_b32 s59, s59, 0
    s_add_u32 s34, s34, s59
    s_sub_u32 s11, s80, s11
    s_max_i32 s11, s11, 0
    s_cmp_eq_u32 s10, s12
    s_cselect_b32 s11, s11, 0
    s_add_u32 s34, s34, s11
    s_sub_u32 s15, s80, s15
    s_max_i32 s15, s15, 0
    s_cmp_eq_u32 s14, s12
    s_cselect_b32 s15, s15, 0
    s_add_u32 s34, s34, s15
    s_sub_i32 s34, s34, 200
    s_max_i32 s34, s34, 0
    s_mul_i32 s34, s34, 36
    s_lshr_b32 s34, s34, 10
    s_min_u32 s34, s34, 40
    s_cmp_eq_u32 s34, 0
    s_cselect_b32 s80, 0, 3
    s_add_u32 s34, s34, s80
    s_add_u32 s12, s35, s34
    s_add_u32 s73, s73, 40
L_cs2:
    s_cmp_lt_u32 s35, s12
    s_cselect_b32 s34, 1, 0
    v_mov_b32 v3, s34
    ds_write_b32 v2, v3 offset:11016
L_cw2:
    s_sleep 2
    s_branch L_cwait
L_go:
    s_cmp_eq_u32 s20, 0
    s_cbranch_scc1 L_rsel
    buffer_load_dword v16, v8, s[44:47], s16 offen offset:0 sc1
    buffer_load_dword v17, v8, s[44:47], s16 offen offset:256 sc1
    buffer_load_dword v18, v8, s[44:47], s16 offen offset:512 sc1
    buffer_load_dword v19, v8, s[44:47], s16 offen offset:768 sc1
    buffer_load_dword v20, v8, s[44:47], s16 offen offset:1024 sc1
    buffer_load_dword v21, v8, s[44:47], s16 offen offset:1280 sc1
    buffer_load_dword v22, v8, s[44:47], s16 offen offset:1536 sc1
    buffer_load_dword v23, v8, s[44:47], s16 offen offset:1792 sc1
    s_branch L_ochk
L_opoll:
    s_nop 4
    s_sub_u32 s75, s75, 1
    s_cbranch_scc1 L_end
    v_cmp_eq_u32 vcc, -1, v16
    s_cbranch_vccz L_osk0
    buffer_load_dword v16, v8, s[44:47], s16 offen offset:0 sc1
L_osk0:
    v_cmp_eq_u32 vcc, -1, v17
    s_cbranch_vccz L_osk1
    buffer_load_dword v17, v8, s[44:47], s16 offen offset:256 sc1
L_osk1:
    v_cmp_eq_u32 vcc, -1, v18
    s_cbranch_vccz L_osk2
    buffer_load_dword v18, v8, s[44:47], s16 offen offset:512 sc1
L_osk2:
    v_cmp_eq_u32 vcc, -1, v19
    s_cbranch_vccz L_osk3
    buffer_load_dword v19, v8, s[44:47], s16 offen offset:768 sc1
L_osk3:
    v_cmp_eq_u32 vcc, -1, v20
    s_cbranch_vccz L_osk4
    buffer_load_dword v20, v8, s[44:47], s16 offen offset:1024 sc1
L_osk4:
    v_cmp_eq_u32 vcc, -1, v21
    s_cbranch_vccz L_osk5
    buffer_load_dword v21, v8, s[44:47], s16 offen offset:1280 sc1
L_osk5:
    v_cmp_eq_u32 vcc, -1, v22
    s_cbranch_vccz L_osk6
    buffer_load_dword v22, v8, s[44:47], s16 offen offset:1536 sc1
L_osk6:
    v_cmp_eq_u32 vcc, -1, v23
    s_cbranch_vccz L_osk7
    buffer_load_dword v23, v8, s[44:47], s16 offen offset:1792 sc1
L_osk7:
L_ochk:
    v_mov_b32 v32, 0
    v_mov_b32 v33, 0
    v_mov_b32 v34, 0
    v_mov_b32 v35, 0
    v_mov_b32 v36, 0
    v_mov_b32 v37, 0
    v_mov_b32 v38, 0
    v_mov_b32 v39, 0
    s_waitcnt vmcnt(0)
    v_max3_u32 v2, v16, v17, v18
    v_max3_u32 v3, v19, v20, v21
    v_add_f32 v24, v16, v17
    v_add_f32 v25, v18, v19
    v_max3_u32 v2, v2, v22, v23
    v_add_f32 v26, v20, v21
    v_add_f32 v27, v22, v23
    v_max_u32 v2, v2, v3
    v_add_f32 v24, v24, v25
    v_cmp_eq_u32 vcc, -1, v2
    v_add_f32 v26, v26, v27
    s_cbranch_vccnz L_opoll
    v_add_f32 v16, v24, v26
    s_nop 1
    v_mov_b32_dpp v17, v16 quad_perm:[1,0,3,2] row_mask:0xf bank_mask:0xf
    v_cvt_pk_bf16_f32 v16, v16, v17
    s_nop 1
    v_mov_b32_dpp v20, v16 row_newbcast:0 row_mask:0xf bank_mask:0x3
    v_mov_b32_dpp v21, v16 row_newbcast:2 row_mask:0xf bank_mask:0x3
    v_mov_b32_dpp v22, v16 row_newbcast:4 row_mask:0xf bank_mask:0x3
    v_mov_b32_dpp v23, v16 row_newbcast:6 row_mask:0xf bank_mask:0x3
    v_mov_b32_dpp v20, v16 row_newbcast:8 row_mask:0xf bank_mask:0xc
    v_mov_b32_dpp v21, v16 row_newbcast:10 row_mask:0xf bank_mask:0xc
    v_mov_b32_dpp v22, v16 row_newbcast:12 row_mask:0xf bank_mask:0xc
    v_mov_b32_dpp v23, v16 row_newbcast:14 row_mask:0xf bank_mask:0xc
    v_dot2c_f32_bf16 v32, v20, v96
    v_dot2c_f32_bf16 v33, v20, v97
    v_dot2c_f32_bf16 v34, v20, v98
    v_dot2c_f32_bf16 v35, v20, v99
    v_dot2c_f32_bf16 v36, v20, v100
    v_dot2c_f32_bf16 v37, v20, v101
    v_dot2c_f32_bf16 v38, v20, v102
    v_dot2c_f32_bf16 v39, v20, v103
    v_dot2c_f32_bf16 v32, v21, v104
    v_dot2c_f32_bf16 v33, v21, v105
    v_dot2c_f32_bf16 v34, v21, v106
    v_dot2c_f32_bf16 v35, v21, v107
    v_dot2c_f32_bf16 v36, v21, v108
    v_dot2c_f32_bf16 v37, v21, v109
    v_dot2c_f32_bf16 v38, v21, v110
    v_dot2c_f32_bf16 v39, v21, v111
    v_dot2c_f32_bf16 v32, v22, v112
    v_dot2c_f32_bf16 v33, v22, v113
    v_dot2c_f32_bf16 v34, v22, v114
    v_dot2c_f32_bf16 v35, v22, v115
    v_dot2c_f32_bf16 v36, v22, v116
    v_dot2c_f32_bf16 v37, v22, v117
    v_dot2c_f32_bf16 v38, v22, v118
    v_dot2c_f32_bf16 v39, v22, v119
    v_dot2c_f32_bf16 v32, v23, v120
    v_dot2c_f32_bf16 v33, v23, v121
    v_dot2c_f32_bf16 v34, v23, v122
    v_dot2c_f32_bf16 v35, v23, v123
    v_dot2c_f32_bf16 v36, v23, v124
    v_dot2c_f32_bf16 v37, v23, v125
    v_dot2c_f32_bf16 v38, v23, v126
    v_dot2c_f32_bf16 v39, v23, v127
    v_permlane32_swap_b32 v32, v36
    v_permlane32_swap_b32 v33, v37
    v_permlane32_swap_b32 v34, v38
    v_permlane32_swap_b32 v35, v39
    v_add_f32 v32, v32, v36
    v_add_f32 v33, v33, v37
    v_add_f32 v34, v34, v38
    v_add_f32 v35, v35, v39
    s_nop 0
    v_permlane16_swap_b32 v32, v34
    v_permlane16_swap_b32 v33, v35
    v_add_f32 v32, v32, v34
    v_add_f32 v33, v33, v35
    s_nop 0
    v_add_f32_dpp v34, v32, v32 row_ror:8 row_mask:0xf bank_mask:0x3
    v_add_f32_dpp v35, v33, v33 row_ror:8 row_mask:0xf bank_mask:0xc
    v_cndmask_b32 v32, v34, v35, s[78:79]
    buffer_store_dword v32, v9, s[44:47], s22 offen sc1
L_rsel:
    s_cmp_eq_u32 s21, 0
    s_cbranch_scc1 L_onext
L_rpoll:
    s_nop 4
    s_sub_u32 s75, s75, 1
    s_cbranch_scc1 L_end
    buffer_load_dwordx4 v[128:131], v14, s[44:47], s25 offen sc1
    buffer_load_dwordx4 v[132:135], v30, s[44:47], s26 offen sc1
    buffer_load_dwordx4 v[136:139], v15, s[44:47], s27 offen sc1
    buffer_load_dwordx4 v[140:143], v15, s[44:47], s68 offen sc1
    buffer_load_dwordx4 v[144:147], v15, s[44:47], s69 offen sc1
    buffer_load_dwordx4 v[148:151], v15, s[44:47], s70 offen sc1
    s_waitcnt vmcnt(0)
    v_max3_u32 v2, v128, v129, v130
    v_max3_u32 v3, v131, v132, v133
    v_max3_u32 v2, v2, v134, v135
    v_max3_u32 v3, v3, v136, v137
    v_max3_u32 v2, v2, v138, v139
    v_max3_u32 v3, v3, v140, v141
    v_max3_u32 v2, v2, v142, v143
    v_max3_u32 v3, v3, v144, v145
    v_max3_u32 v2, v2, v146, v147
    v_max3_u32 v3, v3, v148, v149
    v_max3_u32 v2, v2, v150, v151
    v_max_u32 v2, v2, v3
    v_cmp_eq_u32 vcc, -1, v2
    v_add_f32 v128, v128, v140
    v_add_f32 v129, v129, v141
    v_add_f32 v130, v130, v142
    v_add_f32 v131, v131, v143
    v_add_f32 v132, v132, v144
    v_add_f32 v133, v133, v145
    v_add_f32 v134, v134, v146
    v_add_f32 v135, v135, v147
    v_add_f32 v136, v136, v148
    v_add_f32 v137, v137, v149
    v_add_f32 v138, v138, v150
    v_add_f32 v139, v139, v151
    s_cbranch_vccnz L_rpoll
    v_add_f32 v128, v128, v132
    v_add_f32 v129, v129, v133
    v_add_f32 v130, v130, v134
    v_add_f32 v131, v131, v135
    v_add_f32 v128, v128, v136
    v_add_f32 v129, v129, v137
    v_add_f32 v130, v130, v138
    v_add_f32 v131, v131, v139
    s_nop 0
    v_permlane32_swap_b32 v128, v130
    v_permlane32_swap_b32 v129, v131
    v_add_f32 v128, v128, v130
    v_add_f32 v129, v129, v131
    s_nop 1
    v_permlane16_swap_b32 v128, v129
    v_add_f32 v16, v128, v129
    s_nop 1
    v_add_f32_dpp v16, v16, v16 row_ror:8 row_mask:0xf bank_mask:0xf
    s_nop 1
    v_add_f32_dpp v16, v16, v16 row_ror:4 row_mask:0xf bank_mask:0xf
    v_cvt_pk_bf16_f32 v16, v16, v16
    v_and_b32 v16, 0xffff0000, v16
    v_mul_f32 v16, v16, v13
    v_cvt_pk_bf16_f32 v16, v16, v16
    v_and_b32 v16, 0xffff0000, v16
    v_add_f32 v16, v12, v16
    v_cvt_pk_bf16_f32 v16, v16, v16
    s_cmp_eq_u32 s77, 0
    s_cbranch_scc1 L_gcalc
    buffer_store_short v16, v10, s[64:67], 0 offen
    s_branch L_fin
L_gcalc:
    s_nop 4
    v_and_b32 v16, 0xffff0000, v16
    v_mul_f32 v17, 0xbfb8aa3b, v16
    v_exp_f32 v17, v17
    s_nop 0
    v_add_f32 v17, 1.0, v17
    v_rcp_f32 v17, v17
    s_nop 0
    v_mul_f32 v13, v16, v17
    v_cvt_pk_bf16_f32 v13, v13, v13
    v_and_b32 v13, 0xffff0000, v13
    v_mov_b32 v12, v11
    s_mov_b32 s25, s71
    s_add_u32 s26, s71, 4096
    v_mov_b32 v15, v14
    v_mov_b32 v30, v14
    s_mov_b32 s77, 1
L_onext:
    s_nop 4
    s_add_u32 s16, s16, 6144
    s_add_u32 s22, s22, 245760
    s_add_u32 s17, s17, 1
    s_cmp_lt_u32 s17, 2
    s_cbranch_scc1 L_oloop
L_fin:
    s_nop 4
L_end:
    s_endpgm
.section .rodata,"a"
.p2align 6
.amdhsa_kernel recurrent_scan__mha_block_cached__moe_arch_mod__decode_kernel
  .amdhsa_next_free_vgpr 256
  .amdhsa_next_free_sgpr 102
  .amdhsa_accum_offset 256
  .amdhsa_group_segment_fixed_size 0
  .amdhsa_kernarg_size 104
  .amdhsa_user_sgpr_count 2
  .amdhsa_user_sgpr_kernarg_segment_ptr 1
  .amdhsa_system_sgpr_workgroup_id_x 1
  .amdhsa_float_denorm_mode_32 3
.end_amdhsa_kernel
```
